```python
import torch

def _softmax(x, axis=-1):
    return torch.softmax(x, dim=axis)
def _gelu(x):
    return torch.nn.functional.gelu(x, approximate="tanh")
def _silu(x):
    return torch.nn.functional.silu(x)
def _sigmoid(x):
    return torch.sigmoid(x)
def _layernorm(x, axis=-1, eps=1e-5):
    m = x.mean(dim=axis, keepdim=True)
    v = x.var(dim=axis, keepdim=True, unbiased=False)
    return (x - m) / torch.sqrt(v + eps)
def _scatter_add(tgt, idx, src, axis=0):
    return tgt.clone().index_add_(axis, idx, src)
def _segment_sum(src, seg, n):
    out = torch.zeros((n,) + src.shape[1:], dtype=src.dtype)
    return out.index_add_(0, seg, src)
def _pad(x, pw):
    flat = tuple(v for pair in reversed(pw) for v in pair)
    return torch.nn.functional.pad(x, flat)

kernel_name = 'gated_mix__linear_kernel_hedgehog__sliding_block__prompt'

def setup_inputs():

    _w = (lambda a: (lambda t: t.to(torch.bfloat16) if t.is_floating_point() else t)(torch.as_tensor(a)))
    def _A_setup():
        B, S, D, H = 1, 2048, 576, 32
        Dh = D // H
        return {
            "x": _w((lambda *s: torch.randn(*s, dtype=torch.bfloat16) * 0.05)(B, S, D)),
            "wqkv": _w((lambda *s: torch.randn(*s, dtype=torch.bfloat16) * 1.6)(D, 3 * D)),
            "w_phi": _w((lambda *s: torch.randn(*s, dtype=torch.bfloat16) * 1.6)(H, Dh, Dh) * (Dh ** -0.5)),
            "wo": _w((lambda *s: torch.randn(*s, dtype=torch.bfloat16) * 0.1)(D, D)),
        }
    _A_in = _A_setup()

    def _B_setup():
        B, S, D = 1, 2048, 576
        return {
            "x": _w((lambda *s: torch.randn(*s, dtype=torch.bfloat16) * 0.05)(B, S, D)),
            "wqkv": _w((lambda *s: torch.randn(*s, dtype=torch.bfloat16) * 0.8)(D, 3 * D)),
            "wo": _w((lambda *s: torch.randn(*s, dtype=torch.bfloat16) * 0.05)(D, D)),
        }
    _B_in = _B_setup()

    return {
        "A_x": _A_in["x"],
        "A_wqkv": _A_in["wqkv"],
        "A_w_phi": _A_in["w_phi"],
        "A_wo": _A_in["wo"],
        "B_x": _B_in["x"],
        "B_wqkv": _B_in["wqkv"],
        "B_wo": _B_in["wo"],
        "gate_w": _w((lambda *s: torch.randn(*s, dtype=torch.bfloat16) * 0.05)(576) * 16.0),
    }

def reference(A_x, A_wqkv, A_w_phi, A_wo, B_x, B_wqkv, B_wo, gate_w):
    def _A_ref(x, wqkv, w_phi, wo):
        B, S, D = x.shape
        H = 32; Dh = D // H
        qkv = (lambda x, *d: x.permute(*d))((x @ wqkv).reshape(B, S, 3, H, Dh), 2, 0, 3, 1, 4)
        q, k, v = qkv[0], qkv[1], qkv[2]
        pq = torch.einsum("bhsd,hdf->bhsf", q, w_phi)
        pk = torch.einsum("bhsd,hdf->bhsf", k, w_phi)
        phi_q = torch.concatenate([_softmax(pq, axis=-1), _softmax(-pq, axis=-1)], axis=-1)
        phi_k = torch.concatenate([_softmax(pk, axis=-1), _softmax(-pk, axis=-1)], axis=-1)
        kv = torch.einsum("bhsf,bhsd->bhfd", phi_k, v)
        z  = torch.einsum("bhsf->bhf", phi_k)
        num = torch.einsum("bhqf,bhfd->bhqd", phi_q, kv)
        den = torch.einsum("bhqf,bhf->bhq", phi_q, z)[..., None] + 1e-6
        o = num / den
        return (lambda x, *d: x.permute(*d))(o, 0, 2, 1, 3).reshape(B, S, D) @ wo

    def _B_ref(x, wqkv, wo):
        B, S, D = x.shape
        H = 32; Dh = D // H; W = 256
        qkv = (lambda x, *d: x.permute(*d))((x @ wqkv).reshape(B, S, 3, H, Dh), 2, 0, 3, 1, 4)
        q, k, v = qkv[0], qkv[1], qkv[2]
        scores = torch.einsum("bhqd,bhkd->bhqk", q, k) * (Dh ** -0.5)
        idx = torch.arange(S)
        mask = (idx[:, None] - idx[None, :] >= 0) & (idx[:, None] - idx[None, :] < W)
        scores = torch.where(mask[None, None], scores, -1e9)
        p = _softmax(scores, axis=-1)
        o = torch.einsum("bhqk,bhkd->bhqd", p, v)
        return (lambda x, *d: x.permute(*d))(o, 0, 2, 1, 3).reshape(B, S, D) @ wo

    x = A_x
    g = _sigmoid((x * gate_w).sum(-1, keepdims=True))
    a = _A_ref(x, A_wqkv, A_w_phi, A_wo)
    b = _B_ref(x, B_wqkv, B_wo)
    return g * a + (1 - g) * b
```

```asm
; @launch grid=(256,1,1) block=(256,1,1) lds=163456
.amdgcn_target "amdgcn-amd-amdhsa--gfx950"
.text
.globl gated_mix__linear_kernel_hedgehog__sliding_block__prompt_kernel
.p2align 12
.type gated_mix__linear_kernel_hedgehog__sliding_block__prompt_kernel,@function
gated_mix__linear_kernel_hedgehog__sliding_block__prompt_kernel:
    s_getpc_b64 s[60:61]
    s_load_dwordx16 s[32:47], s[0:1], 0
    s_load_dwordx4 s[48:51], s[0:1], 64
    s_load_dwordx2 s[52:53], s[0:1], 80
    s_memrealtime s[58:59]
    s_cmp_ge_u32 s2, 256
    s_cbranch_scc1 .Lend
    v_lshrrev_b32 v2, 6, v0
    v_and_b32 v1, 63, v0
    v_readfirstlane_b32 s28, v2
    s_lshr_b32 s3, s2, 3
    s_and_b32 s62, s3, 7
    s_lshl_b32 s62, s62, 13
    v_and_b32 v144, 15, v0
    v_lshlrev_b32 v3, 7, v144
    v_lshl_add_u32 v3, v2, 11, v3
    v_add_u32 v3, s62, v3
    v_min_u32 v3, .Lcodeend-gated_mix__linear_kernel_hedgehog__sliding_block__prompt_kernel-8, v3
    global_load_dword v9, v3, s[60:61]
    s_and_b32 s62, s2, 1
    s_lshl_b32 s62, s62, 3
    s_and_b32 s29, s3, 7
    s_or_b32 s29, s29, s62
    s_and_b32 s62, s2, 6
    s_bfe_u32 s30, s3, 0x10003
    s_or_b32 s30, s30, s62
    s_lshr_b32 s31, s3, 4
    s_lshr_b32 s62, s3, 1
    s_and_b32 s62, s62, 12
    s_lshr_b32 s62, 29984, s62
    s_and_b32 s62, s62, 15
    s_and_b32 s63, s3, 7
    s_add_u32 s62, s62, s63
    s_sub_u32 s63, s62, 9
    s_cselect_b32 s62, s62, s63
    s_lshl_b32 s64, s62, 7
    s_mul_i32 s73, s62, 221184
    v_lshrrev_b32 v145, 4, v1
    v_and_b32 v4, 7, v0
    v_xor_b32 v4, v4, v145
    v_lshlrev_b32 v4, 4, v4
    v_xor_b32 v5, 64, v4
    v_lshrrev_b32 v6, 3, v1
    v_lshl_add_u32 v6, v2, 5, v6
    v_mul_u32_u24 v6, 1152, v6
    v_add_u32 v10, v6, v4
    v_add_u32 v5, v6, v5
    v_add_u32 v11, 8192, v5
    v_add_u32 v12, 16384, v10
    v_add_u32 v13, 24576, v5
    s_lshr_b32 s62, s28, 1
    s_lshl_b32 s62, s62, 2
    s_and_b32 s63, s28, 1
    s_add_u32 s89, s62, s63
    s_mul_i32 s99, s89, 27648
    v_add_u32 v4, 0, v1
    v_mul_u32_u24 v5, 171, v4
    v_lshrrev_b32 v5, 11, v5
    v_mad_i32_i24 v4, v5, -12, v4
    v_mul_u32_u24 v6, 22, v4
    v_lshrrev_b32 v6, 6, v6
    v_mad_i32_i24 v4, v6, -3, v4
    v_lshlrev_b32 v4, 4, v4
    v_min_u32 v4, 20, v4
    v_mad_u32_u24 v4, v6, 36, v4
    v_and_b32 v6, 8, v5
    v_add_u32 v5, v5, v6
    v_mul_u32_u24 v5, 3456, v5
    v_add3_u32 v16, v4, v5, s99
    v_add_u32 v4, 64, v1
    v_mul_u32_u24 v5, 171, v4
    v_lshrrev_b32 v5, 11, v5
    v_mad_i32_i24 v4, v5, -12, v4
    v_mul_u32_u24 v6, 22, v4
    v_lshrrev_b32 v6, 6, v6
    v_mad_i32_i24 v4, v6, -3, v4
    v_lshlrev_b32 v4, 4, v4
    v_min_u32 v4, 20, v4
    v_mad_u32_u24 v4, v6, 36, v4
    v_and_b32 v6, 8, v5
    v_add_u32 v5, v5, v6
    v_mul_u32_u24 v5, 3456, v5
    v_add3_u32 v17, v4, v5, s99
    v_subrev_u32 v17, 1024, v17
    v_add_u32 v4, 128, v1
    v_mul_u32_u24 v5, 171, v4
    v_lshrrev_b32 v5, 11, v5
    v_mad_i32_i24 v4, v5, -12, v4
    v_mul_u32_u24 v6, 22, v4
    v_lshrrev_b32 v6, 6, v6
    v_mad_i32_i24 v4, v6, -3, v4
    v_lshlrev_b32 v4, 4, v4
    v_min_u32 v4, 20, v4
    v_mad_u32_u24 v4, v6, 36, v4
    v_and_b32 v6, 8, v5
    v_add_u32 v5, v5, v6
    v_mul_u32_u24 v5, 3456, v5
    v_add3_u32 v18, v4, v5, s99
    v_subrev_u32 v18, 2048, v18
    s_lshl_b32 s55, s28, 12
    s_add_u32 s55, s55, 62080
    s_mul_i32 s56, s28, 3104
    s_mul_i32 s57, s28, 3072
    s_mul_i32 s62, s29, 147456
    s_mul_i32 s90, s30, 144
    s_mul_i32 s3, s31, 1152
    s_add_u32 s63, s90, s3
    s_add_u32 s63, s63, 1152
    s_waitcnt lgkmcnt(0)
    s_add_u32 s4, s32, s62
    s_addc_u32 s5, s33, 0
    s_mov_b32 s6, 2147483647
    s_mov_b32 s7, 0x20000
    s_add_u32 s8, s42, s63
    s_addc_u32 s9, s43, 0
    s_mov_b32 s10, 2147483647
    s_mov_b32 s11, 0x20000
    s_or_b32 s62, s2, s28
    s_cbranch_scc1 .Lnotag
    s_bitset1_b32 s59, 31
    v_mov_b32 v4, s58
    v_mov_b32 v5, s59
    v_lshlrev_b32 v6, 3, v144
    global_store_dwordx2 v6, v[4:5], s[50:51] sc1
.Lnotag:
    s_add_u32 m0, s55, 0
    s_nop 0
    buffer_load_dwordx4 v10, s[4:7], s64 offen offset:0 lds
    buffer_load_dwordx4 v11, s[4:7], s64 offen offset:1024 lds
    buffer_load_dwordx4 v12, s[4:7], s64 offen offset:2048 lds
    buffer_load_dwordx4 v13, s[4:7], s64 offen offset:3072 lds
    s_add_u32 m0, s56, 0
    s_nop 0
    buffer_load_dwordx4 v16, s[8:11], s73 offen offset:0 lds
    buffer_load_dwordx4 v17, s[8:11], s73 offen offset:1024 lds
    buffer_load_dwordx4 v18, s[8:11], s73 offen offset:2048 lds
    s_add_u32 s65, s64, 128
    s_cmp_eq_u32 s65, 1152
    s_cselect_b32 s65, 0, s65
    s_mul_i32 s74, s65, 1728
    s_mov_b32 s24, s46
    s_mov_b32 s25, s47
    s_mov_b32 s26, 1152
    s_mov_b32 s27, 0x20000
    s_lshr_b32 s62, s28, 1
    s_lshl_b32 s62, s62, 6
    s_and_b32 s63, s28, 1
    s_lshl_b32 s63, s63, 4
    s_add_u32 s62, s62, s63
    s_lshl_b32 s88, s28, 10
    s_add_u32 m0, s88, 158336
    v_lshrrev_b32 v4, 1, v1
    v_lshl_add_u32 v4, v4, 7, s64
    v_subrev_u32 v5, 1152, v4
    v_min_u32 v4, v4, v5
    v_and_b32 v5, 1, v0
    v_lshl_add_u32 v4, v5, 5, v4
    buffer_load_dwordx4 v4, s[24:27], s62 offen lds
    s_lshr_b32 s62, s29, 1
    s_mul_i32 s62, s62, 248832
    s_add_u32 s62, s62, s90
    s_add_u32 s63, s3, 1152
    s_bitcmp1_b32 s29, 0
    s_cselect_b32 s63, 0, s63
    s_add_u32 s62, s62, s63
    s_and_b32 s63, s29, s31
    s_cselect_b32 s100, s42, s34
    s_cselect_b32 s101, s43, s35
    s_add_u32 s92, s100, s62
    s_addc_u32 s93, s101, 0
    s_mov_b32 s94, 245520
    s_mov_b32 s95, 0x20000
    s_mul_i32 s91, s28, 7680
    s_add_u32 s91, s91, 123520
    v_mul_u32_u24 v5, 43, v1
    v_lshrrev_b32 v5, 7, v5
    v_mad_i32_i24 v4, v5, -3, v1
    v_lshlrev_b32 v4, 4, v4
    v_min_u32 v4, 20, v4
    v_mad_u32_u24 v207, v5, 36, v4
    s_mov_b32 m0, s91
    s_nop 0
    buffer_load_dwordx4 v16, s[92:95], 0 offen offset:0 lds
    buffer_load_dwordx4 v17, s[92:95], 0 offen offset:1024 lds
    buffer_load_dwordx4 v18, s[92:95], 0 offen offset:2048 lds
    s_mul_i32 s62, s28, 36
    s_add_u32 s62, s62, 218112
    v_mul_u32_u24 v5, 3456, v5
    v_add3_u32 v211, v4, v5, s62
    v_bfe_u32 v5, v0, 2, 3
    v_mul_u32_u24 v5, 3456, v5
    v_and_b32 v4, 3, v0
    v_mad_u32_u24 v4, v4, 36, v5
    v_add_u32 v4, 218132, v4
    v_cmp_le_u32 vcc, 32, v1
    s_nop 1
    v_cndmask_b32 v211, v211, v4, vcc
    buffer_load_dwordx4 v211, s[92:95], 0 offen offset:3072 lds
    s_and_b32 s62, s29, 7
    s_add_u32 s62, s62, 4
    s_sub_u32 s63, s62, 9
    s_cselect_b32 s62, s62, s63
    s_lshl_b32 s62, s62, 7
    s_lshr_b32 s63, s2, 6
    s_lshl2_add_u32 s63, s63, s28
    s_mul_i32 s63, s63, 9216
    s_add_u32 s62, s62, s63
    v_and_b32 v4, 7, v0
    v_mul_u32_u24 v4, 1152, v4
    buffer_load_dword a255, v4, s[4:7], s62 offen
    s_add_u32 s66, s65, 128
    s_cmp_eq_u32 s66, 1152
    s_cselect_b32 s66, 0, s66
    s_mul_i32 s75, s66, 1728
    s_add_u32 s67, s66, 128
    s_cmp_eq_u32 s67, 1152
    s_cselect_b32 s67, 0, s67
    s_mul_i32 s76, s67, 1728
    s_add_u32 s68, s67, 128
    s_cmp_eq_u32 s68, 1152
    s_cselect_b32 s68, 0, s68
    s_mul_i32 s77, s68, 1728
    s_add_u32 s69, s68, 128
    s_cmp_eq_u32 s69, 1152
    s_cselect_b32 s69, 0, s69
    s_mul_i32 s78, s69, 1728
    s_add_u32 s70, s69, 128
    s_cmp_eq_u32 s70, 1152
    s_cselect_b32 s70, 0, s70
    s_mul_i32 s79, s70, 1728
    s_add_u32 s71, s70, 128
    s_cmp_eq_u32 s71, 1152
    s_cselect_b32 s71, 0, s71
    s_mul_i32 s80, s71, 1728
    s_add_u32 s72, s71, 128
    s_cmp_eq_u32 s72, 1152
    s_cselect_b32 s72, 0, s72
    s_mul_i32 s81, s72, 1728
    s_lshl_b32 s98, s30, 1
    s_add_u32 s98, s98, s31
    s_lshl_b32 s54, s29, 4
    s_add_u32 s54, s54, s98
    s_bfe_u32 s63, s54, 0x40001
    s_mul_i32 s63, s63, 41472
    s_lshr_b32 s3, s54, 5
    s_mul_i32 s3, s3, 144
    s_add_u32 s63, s63, s3
    s_bitcmp1_b32 s54, 0
    s_cselect_b32 s100, s38, s44
    s_cselect_b32 s101, s39, s45
    s_add_u32 s84, s100, s63
    s_addc_u32 s85, s101, 0
    s_mov_b32 s86, 40464
    s_mov_b32 s87, 0x20000
    v_add_u32 v4, 0, v0
    v_mul_u32_u24 v5, 57, v4
    v_lshrrev_b32 v5, 9, v5
    v_mad_i32_i24 v4, v5, -9, v4
    v_lshlrev_b32 v4, 4, v4
    v_mul_u32_u24 v5, 1152, v5
    v_add_u32 v208, v4, v5
    v_add_u32 v4, 256, v0
    v_mul_u32_u24 v5, 57, v4
    v_lshrrev_b32 v5, 9, v5
    v_mad_i32_i24 v4, v5, -9, v4
    v_lshlrev_b32 v4, 4, v4
    v_mul_u32_u24 v5, 1152, v5
    v_add_u32 v209, v4, v5
    s_and_b32 s63, s28, 1
    s_lshl_b32 s62, s98, 1
    s_add_u32 s62, s62, s63
    s_mul_i32 s62, s62, 648
    s_add_u32 s24, s36, s62
    s_addc_u32 s25, s37, 0
    s_mov_b32 s26, 648
    s_mov_b32 s27, 0x20000
    v_lshrrev_b32 v4, 2, v1
    s_add_u32 s62, s88, 158336
    v_lshl_add_u32 v210, v4, 1, s62
    v_and_b32 v149, 3, v0
    v_mul_u32_u24 v21, 192, v4
    v_mad_u32_u24 v21, v149, 48, v21
    v_add3_u32 v21, v21, s56, 40
    s_mov_b32 s20, s52
    s_mov_b32 s21, s53
    s_mov_b32 s22, 268435456
    s_mov_b32 s23, 0x20000
    s_mul_i32 s62, s30, 331776
    s_add_u32 s62, s62, 6289408
    s_add_u32 s12, s52, s62
    s_addc_u32 s13, s53, 0
    s_mov_b32 s14, 333824
    s_mov_b32 s15, 0x20000
    s_lshr_b32 s3, s2, 3
    s_lshr_b32 s96, s3, 2
    s_and_b32 s97, s3, 3
    s_and_b32 s62, s2, 1
    s_lshl_b32 s62, s62, 4
    s_add_u32 s97, s97, s62
    s_and_b32 s62, s2, 6
    s_lshl_b32 s62, s62, 1
    s_add_u32 s97, s97, s62
    v_lshrrev_b32 v146, 5, v1
    v_and_b32 v147, 1, v145
    v_bfe_u32 v148, v0, 2, 2
    v_and_b32 v150, 1, v0
    v_bfe_u32 v151, v0, 1, 1
    v_and_b32 v152, 31, v0
    v_lshlrev_b32 v224, 4, v1
    v_lshrrev_b32 v4, 1, v144
    v_xor_b32 v4, v4, v145
    v_lshlrev_b32 v4, 4, v4
    v_lshl_add_u32 v4, v144, 7, v4
    v_add_u32 v14, s55, v4
    v_xor_b32 v15, 64, v14
    v_mul_u32_u24 v4, 3104, v147
    s_movk_i32 s63, 1536
    v_mad_u32_u24 v4, v146, s63, v4
    s_movk_i32 s63, 192
    v_mad_u32_u24 v4, v148, s63, v4
    v_lshl_add_u32 v19, v149, 3, v4
    v_mad_u32_u24 v20, v149, 48, v4
    v_add_u32 v20, 40, v20
    v_mul_u32_u24 v200, 192, v148
    v_add_u32 v200, s91, v200
    v_mad_u32_u24 v200, v145, 48, v200
    v_mad_u32_u24 v200, v149, 8, v200
    v_mul_u32_u24 v4, 192, v148
    v_add_u32 v4, 40, v4
    s_movk_i32 s63, 1536
    v_mad_u32_u24 v4, v147, s63, v4
    v_mad_u32_u24 v4, v149, 48, v4
    v_mul_u32_u24 v5, 48, v148
    v_add_u32 v5, 3072, v5
    v_mad_u32_u24 v5, v149, 8, v5
    v_mul_u32_u24 v6, 16, v144
    v_add_u32 v6, 3592, v6
    v_cmp_eq_u32 vcc, 0, v147
    s_nop 1
    v_cndmask_b32 v5, v6, v5, vcc
    v_lshlrev_b32 v7, 6, v147
    v_add_u32 v7, 192, v7
    v_cmp_eq_u32 vcc, 0, v146
    s_nop 1
    v_cndmask_b32 v4, v5, v4, vcc
    v_add_u32 v201, s91, v4
    v_mov_b32 v6, 768
    v_cndmask_b32 v5, v7, v6, vcc
    v_add_u32 v202, v201, v5
    s_mul_i32 s62, s89, 1152
    v_mov_b32 v4, s62
    v_mov_b32 v5, 6912
    v_cndmask_b32 v4, v5, v4, vcc
    v_mul_u32_u24 v4, 1, v4
    v_add_u32 v4, 992, v4
    s_movk_i32 s63, 2304
    v_mad_u32_u24 v4, v147, s63, v4
    v_mad_u32_u24 v4, v148, 32, v4
    v_mad_u32_u24 v4, v149, 16, v4
    s_lshl_b32 s62, s28, 8
    s_add_u32 s62, s62, 9216
    v_lshl_add_u32 v5, v144, 4, s62
    v_cmp_eq_u32 vcc, 2, v145
    s_nop 1
    v_cndmask_b32 v203, v4, v5, vcc
    s_and_b32 s62, s29, 1
    s_lshl_b32 s62, s62, 1
    s_lshl_b32 s63, s30, 2
    s_add_u32 s62, s62, s63
    s_add_u32 s62, s62, s31
    s_mul_i32 s62, s62, 82944
    s_lshr_b32 s63, s29, 1
    s_mul_i32 s63, s63, 10368
    s_add_u32 s62, s62, s63
    s_add_u32 s82, s62, 6291456
    s_mul_i32 s63, s89, 1152
    s_add_u32 s83, s63, s82
    v_mul_u32_u24 v213, 1024, v146
    v_add_u32 v213, 154240, v213
    v_mad_u32_u24 v213, v148, 48, v213
    v_mul_u32_u24 v212, 16, v147
    v_mad_u32_u24 v212, v151, 8, v212
    v_mad_u32_u24 v212, v213, 1, v212
    v_add_u32 v213, 40, v213
    v_bfe_u32 v4, v0, 2, 1
    v_cmp_eq_u32 vcc, v4, v146
    s_nop 1
    v_cndmask_b32 v214, 0, -1, vcc
    v_mul_u32_u24 v4, 2592, v146
    v_add_u32 v4, 111232, v4
    s_movk_i32 s63, 576
    v_mad_u32_u24 v4, v147, s63, v4
    s_movk_i32 s63, 144
    v_mad_u32_u24 v4, v148, s63, v4
    v_bfe_u32 v6, v0, 2, 1
    v_bfe_u32 v7, v0, 3, 1
    v_mul_u32_u24 v5, 2592, v7
    v_add_u32 v5, 113536, v5
    s_movk_i32 s63, 144
    v_mad_u32_u24 v5, v6, s63, v5
    s_lshr_b32 s62, s28, 1
    s_lshl_b32 s62, s62, 6
    s_and_b32 s3, s28, 1
    s_lshl_b32 s63, s3, 3
    s_add_u32 s62, s62, s63
    v_lshl_add_u32 v204, v149, 4, v4
    v_add_u32 v204, s62, v204
    v_lshlrev_b32 v6, 3, v150
    v_add_u32 v6, 128, v6
    v_and_b32 v7, 7, v0
    s_cmp_ge_u32 s28, 2
    s_cbranch_scc1 .Lrp2
    v_add_u32 v205, v4, v6
    v_lshl_add_u32 v7, v145, 3, v7
    v_lshlrev_b32 v7, 4, v7
    v_add_u32 v206, 4096, v7
    s_branch .Lrp4
.Lrp2:
    s_cmp_eq_u32 s28, 3
    s_cbranch_scc1 .Lrp3
    v_mul_u32_u24 v205, 64, v146
    v_mad_u32_u24 v205, v149, 16, v205
    v_mad_u32_u24 v205, v147, 8, v205
    v_mad_u32_u24 v205, v5, 1, v205
    v_lshlrev_b32 v206, 3, v1
    v_add_u32 v206, 4608, v206
    s_branch .Lrp4
.Lrp3:
    v_add_u32 v205, v5, v6
    v_lshlrev_b32 v206, 3, v144
    v_add_u32 v206, 5120, v206
.Lrp4:
    s_lshl_b32 s62, s31, 9
    s_add_u32 s62, s62, 2048
    v_mul_u32_u24 v31, 1152, v145
    v_add_u32 v31, s62, v31
    v_mad_u32_u24 v31, v144, 16, v31
    v_subrev_u32 v32, 768, v31
    s_and_b32 s63, s28, 1
    s_lshl_b32 s63, s63, 8
    s_add_u32 s63, s63, 80896
    v_add_u32 v34, s63, v31
    s_lshl_b32 s62, s31, 6
    s_add_u32 s62, s62, 1024
    v_mul_u32_u24 v33, 1152, v145
    v_add_u32 v33, s62, v33
    s_mov_b32 s63, 82944
    v_mad_u32_u24 v33, v148, s63, v33
    v_mad_u32_u24 v33, v149, 16, v33
    s_lshr_b32 s62, s64, 6
    s_add_u32 s63, s62, s28
    s_mul_i32 s63, s63, 4608
    s_lshr_b32 s3, s28, 1
    s_mul_i32 s3, s3, 3
    s_add_u32 s62, s62, s3
    s_mul_i32 s62, s62, 4608
    s_sub_u32 s3, s63, 82944
    s_cselect_b32 s32, s63, s3
    s_add_u32 s63, s32, 18432
    s_sub_u32 s3, s63, 82944
    s_cselect_b32 s33, s63, s3
    s_add_u32 s63, s33, 18432
    s_sub_u32 s3, s63, 82944
    s_cselect_b32 s34, s63, s3
    s_add_u32 s63, s34, 18432
    s_sub_u32 s3, s63, 82944
    s_cselect_b32 s35, s63, s3
    s_add_u32 s63, s35, 18432
    s_sub_u32 s3, s63, 82944
    s_cselect_b32 s36, s63, s3
    s_sub_u32 s3, s62, 82944
    s_cselect_b32 s62, s62, s3
    s_add_u32 s37, s62, 2048
    s_add_u32 s62, s62, 4608
    s_sub_u32 s3, s62, 82944
    s_cselect_b32 s62, s62, s3
    s_add_u32 s38, s62, 1024
    s_add_u32 s62, s62, 4608
    s_sub_u32 s3, s62, 82944
    s_cselect_b32 s62, s62, s3
    s_add_u32 s39, s62, 0
    s_add_u32 s62, s62, 18432
    s_sub_u32 s3, s62, 82944
    s_cselect_b32 s62, s62, s3
    s_add_u32 s40, s62, 2048
    s_add_u32 s62, s62, 4608
    s_sub_u32 s3, s62, 82944
    s_cselect_b32 s62, s62, s3
    s_add_u32 s41, s62, 1024
    s_add_u32 s62, s62, 4608
    s_sub_u32 s3, s62, 82944
    s_cselect_b32 s62, s62, s3
    s_add_u32 s42, s62, 0
    s_add_u32 s62, s62, 18432
    s_sub_u32 s3, s62, 82944
    s_cselect_b32 s62, s62, s3
    s_add_u32 s43, s62, 2048
    s_add_u32 s62, s62, 4608
    s_sub_u32 s3, s62, 82944
    s_cselect_b32 s62, s62, s3
    s_add_u32 s44, s62, 1024
    s_add_u32 s62, s62, 4608
    s_sub_u32 s3, s62, 82944
    s_cselect_b32 s62, s62, s3
    s_add_u32 s45, s62, 0
    s_mov_b32 s46, 0x3fb8aa3b
    s_mov_b32 s18, 0x3eae1a93
    v_lshlrev_b32 v4, 2, v146
    v_xor_b32 v4, v4, v144
    v_mul_u32_u24 v35, 512, v146
    v_add_u32 v35, s91, v35
    v_mad_u32_u24 v35, v4, 16, v35
    v_mad_u32_u24 v35, v147, 8, v35
    v_mul_u32_u24 v36, 1280, v145
    v_add_u32 v36, s91, v36
    v_mad_u32_u24 v36, v144, 8, v36
    v_add_u32 v36, 1024, v36
    v_add_u32 v37, s91, v224
    v_mul_u32_u24 v38, 161280, v146
    v_mad_u32_u24 v38, v224, 1, v38
    v_mul_u32_u24 v231, 1280, v146
    v_add_u32 v231, s91, v231
    v_mad_u32_u24 v231, v152, 16, v231
    v_xor_b32 v232, 64, v231
    v_add_u32 v232, 512, v232
    v_mul_u32_u24 v233, 1280, v146
    v_add_u32 v233, s91, v233
    v_mad_u32_u24 v233, v152, 8, v233
    v_add_u32 v233, 1024, v233
    s_lshl_b32 s62, s28, 8
    s_add_u32 s62, s62, 156288
    v_mul_u32_u24 v236, 1024, v146
    v_add_u32 v236, s62, v236
    v_mad_u32_u24 v236, v152, 8, v236
    s_add_u32 s3, s91, 1024
    v_mov_b32 v4, s3
    v_mov_b32 v5, s62
    v_cmp_eq_u32 vcc, 0, v146
    s_nop 1
    v_cndmask_b32 v4, v5, v4, vcc
    v_mov_b32 v5, 2048
    v_mov_b32 v6, 2560
    v_cndmask_b32 v5, v5, v6, vcc
    v_mad_u32_u24 v4, v5, v147, v4
    v_lshl_add_u32 v216, v144, 3, v4
    v_lshrrev_b32 v5, 1, v5
    v_add_u32 v217, v216, v5
    s_add_u32 s62, s62, 2048
    v_lshl_add_u32 v4, v152, 3, s62
    v_mov_b32 v5, 155136
    v_cndmask_b32 v238, v5, v4, vcc
    v_mov_b32 v4, 0x3f803f80
    v_cndmask_b32 v250, 0, v4, vcc
    v_mov_b32 v239, 0x3f80
    v_mov_b32 v249, 0
    v_mov_b32 v251, 0
    v_mov_b32 v252, 0
    v_mov_b32 v253, 0
    v_mov_b32 v4, s18
    v_cmp_eq_u32 vcc, 3, v145
    s_nop 1
    v_cndmask_b32 v218, 1.0, v4, vcc
    v_lshl_add_u32 v4, v146, 2, v148
    v_lshlrev_b32 v5, 2, v151
    v_xor_b32 v5, v5, v4
    v_mul_u32_u24 v6, 512, v151
    v_mad_u32_u24 v6, v5, 16, v6
    v_mad_u32_u24 v6, v150, 8, v6
    v_mul_u32_u24 v7, 8, v4
    v_add_u32 v7, 1024, v7
    v_lshlrev_b32 v5, 2, v150
    v_xor_b32 v5, v5, v4
    v_mul_u32_u24 v8, 512, v150
    v_mad_u32_u24 v8, v5, 16, v8
    v_mad_u32_u24 v8, v151, 8, v8
    s_mul_i32 s62, s28, 2560
    s_add_u32 s62, s62, 62080
    s_add_u32 s3, s62, 30720
    v_cmp_eq_u32 vcc, 0, v147
    s_nop 1
    v_cndmask_b32 v6, v7, v6, vcc
    v_cndmask_b32 v88, v7, v8, vcc
    v_mov_b32 v4, 64
    v_mov_b32 v5, 128
    v_cndmask_b32 v7, v4, v5, vcc
    v_add_u32 v227, s3, v6
    v_lshlrev_b32 v4, 2, v146
    v_xor_b32 v4, v4, v152
    v_mul_u32_u24 v234, 512, v146
    v_add_u32 v234, s62, v234
    v_mad_u32_u24 v234, v4, 16, v234
    v_mul_u32_u24 v235, 8, v152
    v_add_u32 v235, s62, v235
    v_add_u32 v235, 1024, v235
    s_sub_u32 s62, s91, s62
    v_add_u32 v237, s62, v234
    s_and_b32 s62, s28, 1
    s_mul_i32 s62, s62, 1280
    s_lshr_b32 s3, s28, 1
    s_mul_i32 s3, s3, 5120
    s_add_u32 s3, s62, s3
    s_add_u32 s3, s3, 123520
    v_add_u32 v88, s3, v88
    s_add_u32 s62, s62, 126080
    v_add_u32 v92, s62, v6
    v_add_u32 v228, v227, v7
    v_add_u32 v89, v88, v7
    v_add_u32 v93, v92, v7
    v_add_u32 v229, v228, v7
    v_add_u32 v90, v89, v7
    v_add_u32 v94, v93, v7
    v_add_u32 v230, v229, v7
    v_add_u32 v91, v90, v7
    v_add_u32 v95, v94, v7
    v_bfe_u32 v4, v0, 2, 3
    s_lshl_b32 s62, s28, 3
    v_add_u32 v4, s62, v4
    v_lshrrev_b32 v5, 1, v4
    v_and_b32 v6, 1, v4
    v_lshl_add_u32 v5, v5, 4, v6
    s_lshl_b32 s62, s30, 1
    v_add_u32 v5, s62, v5
    s_lshl_b32 s63, s96, 5
    v_add_u32 v4, s63, v4
    v_lshlrev_b32 v6, 7, v149
    v_lshl_add_u32 v223, v4, 9, v6
    v_lshl_add_u32 v222, v5, 9, v6
    s_and_b32 s63, s28, 1
    s_mul_i32 s63, s63, 6
    s_lshl_b32 s3, s29, 2
    s_add_u32 s63, s63, s3
    s_sub_u32 s63, s63, 8
    v_min_u32 v4, 5, v1
    v_add_u32 v4, s63, v4
    v_max_i32 v4, 0, v4
    s_lshr_b32 s63, s28, 1
    s_add_u32 s62, s62, s63
    v_lshrrev_b32 v5, 2, v4
    v_lshl_add_u32 v5, v5, 4, s62
    v_and_b32 v4, 3, v4
    v_lshlrev_b32 v4, 7, v4
    v_lshl_add_u32 v39, v5, 9, v4
    s_lshl2_add_u32 s62, s54, s28
    s_lshl_b32 s62, s62, 7
    v_lshl_add_u32 v1, v144, 3, s62
    s_lshl_b32 s62, s98, 2
    s_add_u32 s62, s62, s28
    v_lshl_add_u32 v4, v144, 6, s62
    v_lshlrev_b32 v242, 7, v4
    s_lshr_b32 s62, s97, 1
    s_lshl_b32 s62, s62, 6
    s_lshl_b32 s3, s28, 4
    s_add_u32 s62, s62, s3
    s_and_b32 s3, s97, 1
    s_lshl_b32 s3, s3, 1
    s_add_u32 s62, s62, s3
    v_bfe_u32 v4, v0, 1, 2
    v_lshl_add_u32 v4, v4, 2, v150
    v_add_u32 v4, s62, v4
    v_lshlrev_b32 v243, 7, v4
    s_lshl_b32 s62, s96, 2
    s_add_u32 s62, s62, s28
    s_mul_i32 s100, s62, 41984
    s_add_u32 s100, s100, 9830400
    v_and_b32 v221, 7, v0
    v_lshl_add_u32 v219, v147, 3, v221
    v_mul_u32_u24 v254, 10496, v146
    v_lshl_add_u32 v219, v219, 4, v254
    v_add_u32 v219, 4096, v219
    v_lshl_add_u32 v254, v152, 4, v254
    v_mul_u32_u24 v220, 10496, v145
    v_add_u32 v220, 4608, v220
    v_lshl_add_u32 v221, v221, 3, v220
    v_lshl_add_u32 v220, v144, 3, v220
    v_mul_u32_u24 v241, 36864, v147
    v_lshl_add_u32 v241, v144, 4, v241
    v_lshl_add_u32 v240, v146, 8, v241
    s_lshl_b32 s62, s29, 2
    s_add_u32 s62, s62, s28
    s_mul_i32 s62, s62, 73728
    s_lshr_b32 s63, s98, 2
    s_mul_i32 s63, s63, 9216
    s_add_u32 s62, s62, s63
    s_add_u32 s62, s62, 11206656
    s_and_b32 s63, s98, 3
    s_lshl_b32 s3, s63, 9
    s_add_u32 s16, s62, s3
    s_lshl_b32 s3, s63, 8
    s_add_u32 s17, s62, s3
    s_add_u32 s17, s17, 8192
    s_add_u32 m0, s55, 16384
    s_nop 0
    buffer_load_dwordx4 v10, s[4:7], s65 offen offset:0 lds
    buffer_load_dwordx4 v11, s[4:7], s65 offen offset:1024 lds
    buffer_load_dwordx4 v12, s[4:7], s65 offen offset:2048 lds
    buffer_load_dwordx4 v13, s[4:7], s65 offen offset:3072 lds
    s_add_u32 m0, s56, 12416
    s_nop 0
    buffer_load_dwordx4 v16, s[8:11], s74 offen offset:0 lds
    buffer_load_dwordx4 v17, s[8:11], s74 offen offset:1024 lds
    buffer_load_dwordx4 v18, s[8:11], s74 offen offset:2048 lds
    s_waitcnt vmcnt(12)
    ds_read_u16 v22, v210 offset:0
    ds_read_u16 v23, v210 offset:32
    ds_read_u16 v24, v210 offset:64
    ds_read_u16 v25, v210 offset:96
    ds_read_u16 v26, v210 offset:128
    ds_read_u16 v27, v210 offset:160
    ds_read_u16 v28, v210 offset:192
    ds_read_u16 v29, v210 offset:224
    ds_read_u16 v30, v210 offset:256
    ds_read_b128 a[0:3], v14 offset:0
    ds_read_b128 a[4:7], v14 offset:2048
    ds_read_b128 a[8:11], v15 offset:0
    ds_read_b128 a[12:15], v15 offset:2048
    v_mov_b32 v246, 0
    global_load_dwordx2 v[246:247], v246, s[50:51] sc1
    s_add_u32 m0, s55, 32768
    s_nop 0
    buffer_load_dwordx4 v10, s[4:7], s66 offen offset:0 lds
    buffer_load_dwordx4 v11, s[4:7], s66 offen offset:1024 lds
    buffer_load_dwordx4 v12, s[4:7], s66 offen offset:2048 lds
    buffer_load_dwordx4 v13, s[4:7], s66 offen offset:3072 lds
    s_waitcnt lgkmcnt(12)
    ds_write_b16 v21, v22 offset:0
    s_waitcnt lgkmcnt(0)
    s_barrier
    ds_read_b64_tr_b16 v[96:97], v19 offset:0
    ds_read_b64_tr_b16 v[98:99], v19 offset:768
    ds_read_b64_tr_b16 v[100:101], v19 offset:48
    ds_read_b64_tr_b16 v[102:103], v19 offset:816
    ds_read_b64_tr_b16 v[104:105], v19 offset:96
    ds_read_b64_tr_b16 v[106:107], v19 offset:864
    ds_read_b64_tr_b16 v[108:109], v19 offset:144
    ds_read_b64_tr_b16 v[110:111], v19 offset:912
    ds_read_b64_tr_b16 v[112:113], v20 offset:0
    ds_read_b64_tr_b16 v[114:115], v20 offset:768
    s_add_u32 m0, s56, 24832
    s_nop 0
    buffer_load_dwordx4 v16, s[8:11], s75 offen offset:0 lds
    buffer_load_dwordx4 v17, s[8:11], s75 offen offset:1024 lds
    buffer_load_dwordx4 v18, s[8:11], s75 offen offset:2048 lds
    s_waitcnt lgkmcnt(0)
    v_mfma_f32_16x16x32_bf16 v[160:163], v[96:99], a[0:3], 0
    ds_read_b64_tr_b16 v[120:121], v19 offset:6208
    ds_read_b64_tr_b16 v[122:123], v19 offset:6976
    s_waitcnt vmcnt(16)
    ds_read_b64_tr_b16 v[40:41], v200 offset:0
    ds_read_b64_tr_b16 v[42:43], v200 offset:768
    ds_read_b64_tr_b16 v[44:45], v200 offset:1536
    ds_read_b64_tr_b16 v[46:47], v200 offset:2304
    ds_read_b64_tr_b16 v[48:49], v201
    ds_read_b64_tr_b16 v[50:51], v202
    v_mfma_f32_16x16x32_bf16 v[164:167], v[96:99], a[4:7], 0
    s_add_u32 m0, s55, 0
    ds_read_b64_tr_b16 v[124:125], v19 offset:6256
    ds_read_b64_tr_b16 v[126:127], v19 offset:7024
    buffer_load_dwordx4 v10, s[4:7], s67 offen offset:0 lds
    v_mfma_f32_16x16x32_bf16 v[168:171], v[100:103], a[0:3], 0
    ds_read_b64_tr_b16 v[128:129], v19 offset:6304
    ds_read_b64_tr_b16 v[130:131], v19 offset:7072
    v_mfma_f32_16x16x32_bf16 v[172:175], v[100:103], a[4:7], 0
    ds_read_b64_tr_b16 v[132:133], v19 offset:6352
    ds_read_b64_tr_b16 v[134:135], v19 offset:7120
    buffer_load_dwordx4 v11, s[4:7], s67 offen offset:1024 lds
    v_mfma_f32_16x16x32_bf16 v[176:179], v[104:107], a[0:3], 0
    s_waitcnt lgkmcnt(8)
    ds_read_b64_tr_b16 v[136:137], v20 offset:6208
    ds_read_b64_tr_b16 v[138:139], v20 offset:6976
    buffer_store_dwordx4 v[40:43], v224, s[20:23], s83 offen offset:0 sc1
    buffer_store_dwordx4 v[44:47], v224, s[20:23], s83 offen offset:2304 sc1
    s_cmp_eq_u32 s28, 0
    s_mov_b32 s62, 0xffff
    s_cselect_b32 exec_hi, 0xccccffff, s62
    s_mov_b32 exec_lo, 0xcccccccc
    s_waitcnt lgkmcnt(8)
    buffer_store_dwordx4 v[48:51], v203, s[20:23], s82 offen sc1
    s_mov_b64 exec, -1
    v_mfma_f32_16x16x32_bf16 v[180:183], v[104:107], a[4:7], 0
    s_waitcnt vmcnt(13)
    ds_write_b16 v21, v23 offset:12416
    v_mfma_f32_16x16x32_bf16 v[184:187], v[108:111], a[0:3], 0
    buffer_load_dwordx4 v12, s[4:7], s67 offen offset:2048 lds
    v_mfma_f32_16x16x32_bf16 v[188:191], v[108:111], a[4:7], 0
    v_mfma_f32_16x16x32_bf16 v[192:195], v[112:115], a[0:3], 0
    buffer_load_dwordx4 v13, s[4:7], s67 offen offset:3072 lds
    v_mfma_f32_16x16x32_bf16 v[196:199], v[112:115], a[4:7], 0
    s_waitcnt lgkmcnt(0)
    s_barrier
    v_mfma_f32_16x16x32_bf16 v[160:163], v[120:123], a[8:11], v[160:163]
    ds_read_b64_tr_b16 v[96:97], v19 offset:12416
    ds_read_b64_tr_b16 v[98:99], v19 offset:13184
    v_mfma_f32_16x16x32_bf16 v[164:167], v[120:123], a[12:15], v[164:167]
    ds_read_b64_tr_b16 v[100:101], v19 offset:12464
    ds_read_b64_tr_b16 v[102:103], v19 offset:13232
    v_mfma_f32_16x16x32_bf16 v[168:171], v[124:127], a[8:11], v[168:171]
    s_add_u32 m0, s56, 37248
    ds_read_b128 a[16:19], v14 offset:16384
    ds_read_b128 a[20:23], v14 offset:18432
    buffer_load_dwordx4 v16, s[8:11], s76 offen offset:0 lds
    v_mfma_f32_16x16x32_bf16 v[172:175], v[124:127], a[12:15], v[172:175]
    ds_read_b64_tr_b16 v[104:105], v19 offset:12512
    ds_read_b64_tr_b16 v[106:107], v19 offset:13280
    v_mfma_f32_16x16x32_bf16 v[176:179], v[128:131], a[8:11], v[176:179]
    ds_read_b64_tr_b16 v[108:109], v19 offset:12560
    ds_read_b64_tr_b16 v[110:111], v19 offset:13328
    v_mfma_f32_16x16x32_bf16 v[180:183], v[128:131], a[12:15], v[180:183]
    ds_read_b64_tr_b16 v[112:113], v20 offset:12416
    ds_read_b64_tr_b16 v[114:115], v20 offset:13184
    buffer_load_dwordx4 v17, s[8:11], s76 offen offset:1024 lds
    v_mfma_f32_16x16x32_bf16 v[184:187], v[132:135], a[8:11], v[184:187]
    ds_read_b128 a[24:27], v15 offset:16384
    ds_read_b128 a[28:31], v15 offset:18432
    v_mfma_f32_16x16x32_bf16 v[188:191], v[132:135], a[12:15], v[188:191]
    s_waitcnt lgkmcnt(8)
    v_mfma_f32_16x16x32_bf16 v[192:195], v[136:139], a[8:11], v[192:195]
    buffer_load_dwordx4 v18, s[8:11], s76 offen offset:2048 lds
    v_mfma_f32_16x16x32_bf16 v[196:199], v[136:139], a[12:15], v[196:199]
    s_waitcnt lgkmcnt(0)
    v_mfma_f32_16x16x32_bf16 v[160:163], v[96:99], a[16:19], v[160:163]
    ds_read_b64_tr_b16 v[120:121], v19 offset:18624
    ds_read_b64_tr_b16 v[122:123], v19 offset:19392
    v_mfma_f32_16x16x32_bf16 v[164:167], v[96:99], a[20:23], v[164:167]
    s_add_u32 m0, s55, 16384
    ds_read_b64_tr_b16 v[124:125], v19 offset:18672
    ds_read_b64_tr_b16 v[126:127], v19 offset:19440
    buffer_load_dwordx4 v10, s[4:7], s68 offen offset:0 lds
    v_mfma_f32_16x16x32_bf16 v[168:171], v[100:103], a[16:19], v[168:171]
    ds_read_b64_tr_b16 v[128:129], v19 offset:18720
    ds_read_b64_tr_b16 v[130:131], v19 offset:19488
    v_mfma_f32_16x16x32_bf16 v[172:175], v[100:103], a[20:23], v[172:175]
    ds_read_b64_tr_b16 v[132:133], v19 offset:18768
    ds_read_b64_tr_b16 v[134:135], v19 offset:19536
    buffer_load_dwordx4 v11, s[4:7], s68 offen offset:1024 lds
    v_mfma_f32_16x16x32_bf16 v[176:179], v[104:107], a[16:19], v[176:179]
    ds_read_b64_tr_b16 v[136:137], v20 offset:18624
    ds_read_b64_tr_b16 v[138:139], v20 offset:19392
    v_mfma_f32_16x16x32_bf16 v[180:183], v[104:107], a[20:23], v[180:183]
    s_waitcnt vmcnt(12)
    ds_write_b16 v21, v24 offset:24832
    v_mfma_f32_16x16x32_bf16 v[184:187], v[108:111], a[16:19], v[184:187]
    buffer_load_dwordx4 v12, s[4:7], s68 offen offset:2048 lds
    v_mfma_f32_16x16x32_bf16 v[188:191], v[108:111], a[20:23], v[188:191]
    v_mfma_f32_16x16x32_bf16 v[192:195], v[112:115], a[16:19], v[192:195]
    buffer_load_dwordx4 v13, s[4:7], s68 offen offset:3072 lds
    v_mfma_f32_16x16x32_bf16 v[196:199], v[112:115], a[20:23], v[196:199]
    s_waitcnt lgkmcnt(0)
    s_barrier
    v_mfma_f32_16x16x32_bf16 v[160:163], v[120:123], a[24:27], v[160:163]
    ds_read_b64_tr_b16 v[96:97], v19 offset:24832
    ds_read_b64_tr_b16 v[98:99], v19 offset:25600
    v_mfma_f32_16x16x32_bf16 v[164:167], v[120:123], a[28:31], v[164:167]
    ds_read_b64_tr_b16 v[100:101], v19 offset:24880
    ds_read_b64_tr_b16 v[102:103], v19 offset:25648
    v_mfma_f32_16x16x32_bf16 v[168:171], v[124:127], a[24:27], v[168:171]
    s_add_u32 m0, s56, 49664
    ds_read_b128 a[32:35], v14 offset:32768
    ds_read_b128 a[36:39], v14 offset:34816
    buffer_load_dwordx4 v16, s[8:11], s77 offen offset:0 lds
    v_mfma_f32_16x16x32_bf16 v[172:175], v[124:127], a[28:31], v[172:175]
    ds_read_b64_tr_b16 v[104:105], v19 offset:24928
    ds_read_b64_tr_b16 v[106:107], v19 offset:25696
    v_mfma_f32_16x16x32_bf16 v[176:179], v[128:131], a[24:27], v[176:179]
    ds_read_b64_tr_b16 v[108:109], v19 offset:24976
    ds_read_b64_tr_b16 v[110:111], v19 offset:25744
    v_mfma_f32_16x16x32_bf16 v[180:183], v[128:131], a[28:31], v[180:183]
    ds_read_b64_tr_b16 v[112:113], v20 offset:24832
    ds_read_b64_tr_b16 v[114:115], v20 offset:25600
    buffer_load_dwordx4 v17, s[8:11], s77 offen offset:1024 lds
    v_mfma_f32_16x16x32_bf16 v[184:187], v[132:135], a[24:27], v[184:187]
    ds_read_b128 a[40:43], v15 offset:32768
    ds_read_b128 a[44:47], v15 offset:34816
    v_mfma_f32_16x16x32_bf16 v[188:191], v[132:135], a[28:31], v[188:191]
    v_mfma_f32_16x16x32_bf16 v[192:195], v[136:139], a[24:27], v[192:195]
    buffer_load_dwordx4 v18, s[8:11], s77 offen offset:2048 lds
    v_mfma_f32_16x16x32_bf16 v[196:199], v[136:139], a[28:31], v[196:199]
    v_readfirstlane_b32 s59, v247
    s_mov_b32 s63, 300000
    s_cmp_lg_u32 s59, 0
    s_cbranch_scc1 .Ltag2
.Ltag:
    v_mov_b32 v246, 0
    global_load_dwordx2 v[246:247], v246, s[50:51] sc1
    s_waitcnt vmcnt(0)
    v_readfirstlane_b32 s59, v247
    s_sub_u32 s63, s63, 1
    s_cbranch_scc1 .Lend
    s_cmp_eq_u32 s59, 0
    s_cbranch_scc1 .Ltag
.Ltag2:
    v_readfirstlane_b32 s58, v246
    s_waitcnt vmcnt(12)
    s_mov_b32 s62, 524288
    buffer_store_dwordx2 v[246:247], v1, s[20:23], s62 offen sc1
    s_waitcnt lgkmcnt(0)
    v_mfma_f32_16x16x32_bf16 v[160:163], v[96:99], a[32:35], v[160:163]
    ds_read_b64_tr_b16 v[120:121], v19 offset:31040
    ds_read_b64_tr_b16 v[122:123], v19 offset:31808
    v_mfma_f32_16x16x32_bf16 v[164:167], v[96:99], a[36:39], v[164:167]
    s_add_u32 m0, s55, 32768
    ds_read_b64_tr_b16 v[124:125], v19 offset:31088
    ds_read_b64_tr_b16 v[126:127], v19 offset:31856
    buffer_load_dwordx4 v10, s[4:7], s69 offen offset:0 lds
    v_mfma_f32_16x16x32_bf16 v[168:171], v[100:103], a[32:35], v[168:171]
    ds_read_b64_tr_b16 v[128:129], v19 offset:31136
    ds_read_b64_tr_b16 v[130:131], v19 offset:31904
    v_mfma_f32_16x16x32_bf16 v[172:175], v[100:103], a[36:39], v[172:175]
    ds_read_b64_tr_b16 v[132:133], v19 offset:31184
    ds_read_b64_tr_b16 v[134:135], v19 offset:31952
    buffer_load_dwordx4 v11, s[4:7], s69 offen offset:1024 lds
    v_mfma_f32_16x16x32_bf16 v[176:179], v[104:107], a[32:35], v[176:179]
    ds_read_b64_tr_b16 v[136:137], v20 offset:31040
    ds_read_b64_tr_b16 v[138:139], v20 offset:31808
    v_mfma_f32_16x16x32_bf16 v[180:183], v[104:107], a[36:39], v[180:183]
    s_waitcnt vmcnt(10)
    ds_write_b16 v21, v25 offset:37248
    v_mfma_f32_16x16x32_bf16 v[184:187], v[108:111], a[32:35], v[184:187]
    buffer_load_dwordx4 v12, s[4:7], s69 offen offset:2048 lds
    v_mfma_f32_16x16x32_bf16 v[188:191], v[108:111], a[36:39], v[188:191]
    v_mfma_f32_16x16x32_bf16 v[192:195], v[112:115], a[32:35], v[192:195]
    buffer_load_dwordx4 v13, s[4:7], s69 offen offset:3072 lds
    s_add_u32 m0, s88, 111232
    v_mfma_f32_16x16x32_bf16 v[196:199], v[112:115], a[36:39], v[196:199]
    buffer_load_dwordx4 v208, s[84:87], 0 offen lds
    s_add_u32 m0, s88, 115328
    s_nop 0
    buffer_load_dwordx4 v209, s[84:87], 0 offen lds
    s_and_b32 s63, s88, 1024
    s_add_u32 m0, s63, 154240
    s_nop 0
    buffer_load_dwordx4 v207, s[24:27], 0 offen lds
    s_waitcnt lgkmcnt(0)
    s_barrier
    v_mfma_f32_16x16x32_bf16 v[160:163], v[120:123], a[40:43], v[160:163]
    ds_read_b64_tr_b16 v[96:97], v19 offset:37248
    ds_read_b64_tr_b16 v[98:99], v19 offset:38016
    v_mfma_f32_16x16x32_bf16 v[164:167], v[120:123], a[44:47], v[164:167]
    ds_read_b64_tr_b16 v[100:101], v19 offset:37296
    ds_read_b64_tr_b16 v[102:103], v19 offset:38064
    v_mfma_f32_16x16x32_bf16 v[168:171], v[124:127], a[40:43], v[168:171]
    s_add_u32 m0, s56, 0
    ds_read_b128 a[48:51], v14 offset:0
    ds_read_b128 a[52:55], v14 offset:2048
    buffer_load_dwordx4 v16, s[8:11], s78 offen offset:0 lds
    v_mfma_f32_16x16x32_bf16 v[172:175], v[124:127], a[44:47], v[172:175]
    ds_read_b64_tr_b16 v[104:105], v19 offset:37344
    ds_read_b64_tr_b16 v[106:107], v19 offset:38112
    v_mfma_f32_16x16x32_bf16 v[176:179], v[128:131], a[40:43], v[176:179]
    ds_read_b64_tr_b16 v[108:109], v19 offset:37392
    ds_read_b64_tr_b16 v[110:111], v19 offset:38160
    v_mfma_f32_16x16x32_bf16 v[180:183], v[128:131], a[44:47], v[180:183]
    ds_read_b64_tr_b16 v[112:113], v20 offset:37248
    ds_read_b64_tr_b16 v[114:115], v20 offset:38016
    buffer_load_dwordx4 v17, s[8:11], s78 offen offset:1024 lds
    v_mfma_f32_16x16x32_bf16 v[184:187], v[132:135], a[40:43], v[184:187]
    ds_read_b128 a[56:59], v15 offset:0
    ds_read_b128 a[60:63], v15 offset:2048
    v_mfma_f32_16x16x32_bf16 v[188:191], v[132:135], a[44:47], v[188:191]
    s_waitcnt lgkmcnt(8)
    v_mfma_f32_16x16x32_bf16 v[192:195], v[136:139], a[40:43], v[192:195]
    buffer_load_dwordx4 v18, s[8:11], s78 offen offset:2048 lds
    v_mfma_f32_16x16x32_bf16 v[196:199], v[136:139], a[44:47], v[196:199]
    s_waitcnt lgkmcnt(0)
    v_mfma_f32_16x16x32_bf16 v[160:163], v[96:99], a[48:51], v[160:163]
    ds_read_b64_tr_b16 v[120:121], v19 offset:43456
    ds_read_b64_tr_b16 v[122:123], v19 offset:44224
    v_mfma_f32_16x16x32_bf16 v[164:167], v[96:99], a[52:55], v[164:167]
    s_add_u32 m0, s55, 0
    ds_read_b64_tr_b16 v[124:125], v19 offset:43504
    ds_read_b64_tr_b16 v[126:127], v19 offset:44272
    buffer_load_dwordx4 v10, s[4:7], s70 offen offset:0 lds
    v_mfma_f32_16x16x32_bf16 v[168:171], v[100:103], a[48:51], v[168:171]
    ds_read_b64_tr_b16 v[128:129], v19 offset:43552
    ds_read_b64_tr_b16 v[130:131], v19 offset:44320
    v_mfma_f32_16x16x32_bf16 v[172:175], v[100:103], a[52:55], v[172:175]
    ds_read_b64_tr_b16 v[132:133], v19 offset:43600
    ds_read_b64_tr_b16 v[134:135], v19 offset:44368
    buffer_load_dwordx4 v11, s[4:7], s70 offen offset:1024 lds
    v_mfma_f32_16x16x32_bf16 v[176:179], v[104:107], a[48:51], v[176:179]
    ds_read_b64_tr_b16 v[136:137], v20 offset:43456
    ds_read_b64_tr_b16 v[138:139], v20 offset:44224
    v_mfma_f32_16x16x32_bf16 v[180:183], v[104:107], a[52:55], v[180:183]
    s_waitcnt vmcnt(13)
    ds_write_b16 v21, v26 offset:49664
    v_mfma_f32_16x16x32_bf16 v[184:187], v[108:111], a[48:51], v[184:187]
    buffer_load_dwordx4 v12, s[4:7], s70 offen offset:2048 lds
    v_mfma_f32_16x16x32_bf16 v[188:191], v[108:111], a[52:55], v[188:191]
    v_mfma_f32_16x16x32_bf16 v[192:195], v[112:115], a[48:51], v[192:195]
    buffer_load_dwordx4 v13, s[4:7], s70 offen offset:3072 lds
    v_mfma_f32_16x16x32_bf16 v[196:199], v[112:115], a[52:55], v[196:199]
    s_waitcnt lgkmcnt(0)
    s_barrier
    v_mfma_f32_16x16x32_bf16 v[160:163], v[120:123], a[56:59], v[160:163]
    ds_read_b64_tr_b16 v[96:97], v19 offset:49664
    ds_read_b64_tr_b16 v[98:99], v19 offset:50432
    v_mfma_f32_16x16x32_bf16 v[164:167], v[120:123], a[60:63], v[164:167]
    ds_read_b64_tr_b16 v[100:101], v19 offset:49712
    ds_read_b64_tr_b16 v[102:103], v19 offset:50480
    v_mfma_f32_16x16x32_bf16 v[168:171], v[124:127], a[56:59], v[168:171]
    s_add_u32 m0, s56, 12416
    ds_read_b128 a[64:67], v14 offset:16384
    ds_read_b128 a[68:71], v14 offset:18432
    buffer_load_dwordx4 v16, s[8:11], s79 offen offset:0 lds
    v_mfma_f32_16x16x32_bf16 v[172:175], v[124:127], a[60:63], v[172:175]
    ds_read_b64_tr_b16 v[104:105], v19 offset:49760
    ds_read_b64_tr_b16 v[106:107], v19 offset:50528
    v_mfma_f32_16x16x32_bf16 v[176:179], v[128:131], a[56:59], v[176:179]
    ds_read_b64_tr_b16 v[108:109], v19 offset:49808
    ds_read_b64_tr_b16 v[110:111], v19 offset:50576
    v_mfma_f32_16x16x32_bf16 v[180:183], v[128:131], a[60:63], v[180:183]
    ds_read_b64_tr_b16 v[112:113], v20 offset:49664
    ds_read_b64_tr_b16 v[114:115], v20 offset:50432
    buffer_load_dwordx4 v17, s[8:11], s79 offen offset:1024 lds
    v_mfma_f32_16x16x32_bf16 v[184:187], v[132:135], a[56:59], v[184:187]
    ds_read_b128 a[72:75], v15 offset:16384
    ds_read_b128 a[76:79], v15 offset:18432
    v_mfma_f32_16x16x32_bf16 v[188:191], v[132:135], a[60:63], v[188:191]
    s_waitcnt lgkmcnt(8)
    v_mfma_f32_16x16x32_bf16 v[192:195], v[136:139], a[56:59], v[192:195]
    buffer_load_dwordx4 v18, s[8:11], s79 offen offset:2048 lds
    v_mfma_f32_16x16x32_bf16 v[196:199], v[136:139], a[60:63], v[196:199]
    s_waitcnt lgkmcnt(0)
    v_mfma_f32_16x16x32_bf16 v[160:163], v[96:99], a[64:67], v[160:163]
    ds_read_b64_tr_b16 v[120:121], v19 offset:55872
    ds_read_b64_tr_b16 v[122:123], v19 offset:56640
    v_mfma_f32_16x16x32_bf16 v[164:167], v[96:99], a[68:71], v[164:167]
    s_add_u32 m0, s55, 16384
    ds_read_b64_tr_b16 v[124:125], v19 offset:55920
    ds_read_b64_tr_b16 v[126:127], v19 offset:56688
    buffer_load_dwordx4 v10, s[4:7], s71 offen offset:0 lds
    v_mfma_f32_16x16x32_bf16 v[168:171], v[100:103], a[64:67], v[168:171]
    ds_read_b64_tr_b16 v[128:129], v19 offset:55968
    ds_read_b64_tr_b16 v[130:131], v19 offset:56736
    v_mfma_f32_16x16x32_bf16 v[172:175], v[100:103], a[68:71], v[172:175]
    ds_read_b64_tr_b16 v[132:133], v19 offset:56016
    ds_read_b64_tr_b16 v[134:135], v19 offset:56784
    buffer_load_dwordx4 v11, s[4:7], s71 offen offset:1024 lds
    v_mfma_f32_16x16x32_bf16 v[176:179], v[104:107], a[64:67], v[176:179]
    ds_read_b64_tr_b16 v[136:137], v20 offset:55872
    ds_read_b64_tr_b16 v[138:139], v20 offset:56640
    v_mfma_f32_16x16x32_bf16 v[180:183], v[104:107], a[68:71], v[180:183]
    s_waitcnt vmcnt(9)
    ds_write_b16 v21, v27 offset:0
    v_mfma_f32_16x16x32_bf16 v[184:187], v[108:111], a[64:67], v[184:187]
    buffer_load_dwordx4 v12, s[4:7], s71 offen offset:2048 lds
    v_mfma_f32_16x16x32_bf16 v[188:191], v[108:111], a[68:71], v[188:191]
    v_mfma_f32_16x16x32_bf16 v[192:195], v[112:115], a[64:67], v[192:195]
    buffer_load_dwordx4 v13, s[4:7], s71 offen offset:3072 lds
    v_mfma_f32_16x16x32_bf16 v[196:199], v[112:115], a[68:71], v[196:199]
    s_waitcnt lgkmcnt(0)
    s_barrier
    v_mfma_f32_16x16x32_bf16 v[160:163], v[120:123], a[72:75], v[160:163]
    ds_read_b64_tr_b16 v[96:97], v19 offset:0
    ds_read_b64_tr_b16 v[98:99], v19 offset:768
    v_mfma_f32_16x16x32_bf16 v[164:167], v[120:123], a[76:79], v[164:167]
    ds_read_b64_tr_b16 v[100:101], v19 offset:48
    ds_read_b64_tr_b16 v[102:103], v19 offset:816
    v_mfma_f32_16x16x32_bf16 v[168:171], v[124:127], a[72:75], v[168:171]
    s_add_u32 m0, s56, 24832
    ds_read_b128 a[80:83], v14 offset:32768
    ds_read_b128 a[84:87], v14 offset:34816
    buffer_load_dwordx4 v16, s[8:11], s80 offen offset:0 lds
    v_mfma_f32_16x16x32_bf16 v[172:175], v[124:127], a[76:79], v[172:175]
    ds_read_b64_tr_b16 v[104:105], v19 offset:96
    ds_read_b64_tr_b16 v[106:107], v19 offset:864
    v_mfma_f32_16x16x32_bf16 v[176:179], v[128:131], a[72:75], v[176:179]
    ds_read_b64_tr_b16 v[108:109], v19 offset:144
    ds_read_b64_tr_b16 v[110:111], v19 offset:912
    v_mfma_f32_16x16x32_bf16 v[180:183], v[128:131], a[76:79], v[180:183]
    ds_read_b64_tr_b16 v[112:113], v20 offset:0
    ds_read_b64_tr_b16 v[114:115], v20 offset:768
    buffer_load_dwordx4 v17, s[8:11], s80 offen offset:1024 lds
    v_mfma_f32_16x16x32_bf16 v[184:187], v[132:135], a[72:75], v[184:187]
    ds_read_b128 a[88:91], v15 offset:32768
    ds_read_b128 a[92:95], v15 offset:34816
    v_mfma_f32_16x16x32_bf16 v[188:191], v[132:135], a[76:79], v[188:191]
    s_waitcnt lgkmcnt(8)
    v_mfma_f32_16x16x32_bf16 v[192:195], v[136:139], a[72:75], v[192:195]
    buffer_load_dwordx4 v18, s[8:11], s80 offen offset:2048 lds
    v_mfma_f32_16x16x32_bf16 v[196:199], v[136:139], a[76:79], v[196:199]
    s_waitcnt lgkmcnt(0)
    v_mfma_f32_16x16x32_bf16 v[160:163], v[96:99], a[80:83], v[160:163]
    ds_read_b64_tr_b16 v[120:121], v19 offset:6208
    ds_read_b64_tr_b16 v[122:123], v19 offset:6976
    v_mfma_f32_16x16x32_bf16 v[164:167], v[96:99], a[84:87], v[164:167]
    s_add_u32 m0, s55, 32768
    ds_read_b64_tr_b16 v[124:125], v19 offset:6256
    ds_read_b64_tr_b16 v[126:127], v19 offset:7024
    buffer_load_dwordx4 v10, s[4:7], s72 offen offset:0 lds
    v_mfma_f32_16x16x32_bf16 v[168:171], v[100:103], a[80:83], v[168:171]
    ds_read_b64_tr_b16 v[128:129], v19 offset:6304
    ds_read_b64_tr_b16 v[130:131], v19 offset:7072
    v_mfma_f32_16x16x32_bf16 v[172:175], v[100:103], a[84:87], v[172:175]
    ds_read_b64_tr_b16 v[132:133], v19 offset:6352
    ds_read_b64_tr_b16 v[134:135], v19 offset:7120
    buffer_load_dwordx4 v11, s[4:7], s72 offen offset:1024 lds
    v_mfma_f32_16x16x32_bf16 v[176:179], v[104:107], a[80:83], v[176:179]
    ds_read_b64_tr_b16 v[136:137], v20 offset:6208
    ds_read_b64_tr_b16 v[138:139], v20 offset:6976
    v_mfma_f32_16x16x32_bf16 v[180:183], v[104:107], a[84:87], v[180:183]
    s_waitcnt vmcnt(9)
    ds_write_b16 v21, v28 offset:12416
    v_mfma_f32_16x16x32_bf16 v[184:187], v[108:111], a[80:83], v[184:187]
    buffer_load_dwordx4 v12, s[4:7], s72 offen offset:2048 lds
    v_mfma_f32_16x16x32_bf16 v[188:191], v[108:111], a[84:87], v[188:191]
    v_mfma_f32_16x16x32_bf16 v[192:195], v[112:115], a[80:83], v[192:195]
    buffer_load_dwordx4 v13, s[4:7], s72 offen offset:3072 lds
    v_mfma_f32_16x16x32_bf16 v[196:199], v[112:115], a[84:87], v[196:199]
    s_waitcnt lgkmcnt(0)
    s_barrier
    v_mfma_f32_16x16x32_bf16 v[160:163], v[120:123], a[88:91], v[160:163]
    ds_read_b64_tr_b16 v[96:97], v19 offset:12416
    ds_read_b64_tr_b16 v[98:99], v19 offset:13184
    v_mfma_f32_16x16x32_bf16 v[164:167], v[120:123], a[92:95], v[164:167]
    ds_read_b64_tr_b16 v[100:101], v19 offset:12464
    ds_read_b64_tr_b16 v[102:103], v19 offset:13232
    v_mfma_f32_16x16x32_bf16 v[168:171], v[124:127], a[88:91], v[168:171]
    s_add_u32 m0, s56, 37248
    ds_read_b128 a[96:99], v14 offset:0
    ds_read_b128 a[100:103], v14 offset:2048
    buffer_load_dwordx4 v16, s[8:11], s81 offen offset:0 lds
    v_mfma_f32_16x16x32_bf16 v[172:175], v[124:127], a[92:95], v[172:175]
    ds_read_b64_tr_b16 v[104:105], v19 offset:12512
    ds_read_b64_tr_b16 v[106:107], v19 offset:13280
    v_mfma_f32_16x16x32_bf16 v[176:179], v[128:131], a[88:91], v[176:179]
    ds_read_b64_tr_b16 v[108:109], v19 offset:12560
    ds_read_b64_tr_b16 v[110:111], v19 offset:13328
    v_mfma_f32_16x16x32_bf16 v[180:183], v[128:131], a[92:95], v[180:183]
    ds_read_b64_tr_b16 v[112:113], v20 offset:12416
    ds_read_b64_tr_b16 v[114:115], v20 offset:13184
    buffer_load_dwordx4 v17, s[8:11], s81 offen offset:1024 lds
    v_mfma_f32_16x16x32_bf16 v[184:187], v[132:135], a[88:91], v[184:187]
    ds_read_b128 a[104:107], v15 offset:0
    ds_read_b128 a[108:111], v15 offset:2048
    v_mfma_f32_16x16x32_bf16 v[188:191], v[132:135], a[92:95], v[188:191]
    s_waitcnt lgkmcnt(8)
    ds_read_b64_tr_b16 v[52:53], v204
    ds_read_b64_tr_b16 v[54:55], v204 offset:1152
    ds_read_b64_tr_b16 v[56:57], v205
    ds_read_b64_tr_b16 v[58:59], v205 offset:1152
    v_mfma_f32_16x16x32_bf16 v[192:195], v[136:139], a[88:91], v[192:195]
    s_waitcnt lgkmcnt(9)
    buffer_load_dwordx4 v18, s[8:11], s81 offen offset:2048 lds
    v_mfma_f32_16x16x32_bf16 v[196:199], v[136:139], a[92:95], v[196:199]
    s_mov_b32 s62, 524288
    buffer_load_dwordx2 v[244:245], v222, s[20:23], s62 offen sc1
    s_waitcnt lgkmcnt(4)
    v_mfma_f32_16x16x32_bf16 v[160:163], v[96:99], a[96:99], v[160:163]
    ds_read_b64_tr_b16 v[120:121], v19 offset:18624
    ds_read_b64_tr_b16 v[122:123], v19 offset:19392
    v_mfma_f32_16x16x32_bf16 v[164:167], v[96:99], a[100:103], v[164:167]
    ds_read_b64_tr_b16 v[124:125], v19 offset:18672
    ds_read_b64_tr_b16 v[126:127], v19 offset:19440
    v_mfma_f32_16x16x32_bf16 v[168:171], v[100:103], a[96:99], v[168:171]
    ds_read_b64_tr_b16 v[128:129], v19 offset:18720
    ds_read_b64_tr_b16 v[130:131], v19 offset:19488
    v_mfma_f32_16x16x32_bf16 v[172:175], v[100:103], a[100:103], v[172:175]
    ds_read_b64_tr_b16 v[132:133], v19 offset:18768
    ds_read_b64_tr_b16 v[134:135], v19 offset:19536
    v_mfma_f32_16x16x32_bf16 v[176:179], v[104:107], a[96:99], v[176:179]
    ds_read_b64_tr_b16 v[136:137], v20 offset:18624
    ds_read_b64_tr_b16 v[138:139], v20 offset:19392
    v_mfma_f32_16x16x32_bf16 v[180:183], v[104:107], a[100:103], v[180:183]
    s_waitcnt vmcnt(8)
    ds_write_b16 v21, v29 offset:24832
    v_mfma_f32_16x16x32_bf16 v[184:187], v[108:111], a[96:99], v[184:187]
    v_mfma_f32_16x16x32_bf16 v[188:191], v[108:111], a[100:103], v[188:191]
    s_waitcnt lgkmcnt(11)
    v_mfma_f32_16x16x32_bf16 v[192:195], v[112:115], a[96:99], v[192:195]
    v_mfma_f32_16x16x32_bf16 v[196:199], v[112:115], a[100:103], v[196:199]
    s_mul_i32 s63, s54, 5248
    s_add_u32 s63, s63, 9830400
    s_add_u32 s3, s88, s63
    buffer_store_dwordx4 v[52:55], v224, s[20:23], s3 offen sc1
    s_cmp_ge_u32 s28, 2
    s_cbranch_scc1 .Lw2
    s_cmp_eq_u32 s28, 0
    s_cselect_b32 exec_lo, -1, 0
    s_cselect_b32 exec_hi, 0, -1
    buffer_store_dwordx4 v[56:59], v206, s[20:23], s63 offen sc1
    s_mov_b64 exec, -1
    s_branch .Lw3
.Lw2:
    buffer_store_dwordx2 v[56:57], v206, s[20:23], s63 offen sc1
.Lw3:
    s_nop 1
    s_waitcnt vmcnt(2)
    v_cmp_ne_u64 vcc, s[58:59], v[244:245]
    s_cbranch_vccz .Lqfw
    s_mov_b32 s62, 524288
    s_mov_b32 s63, 300000
.Lpfw:
    buffer_load_dwordx2 v[244:245], v222, s[20:23], s62 offen sc1
    s_waitcnt vmcnt(0)
    v_cmp_ne_u64 vcc, s[58:59], v[244:245]
    s_sub_u32 s63, s63, 1
    s_cbranch_scc1 .Lend
    s_cbranch_vccnz .Lpfw
.Lqfw:
    s_waitcnt lgkmcnt(0)
    s_barrier
    v_mfma_f32_16x16x32_bf16 v[160:163], v[120:123], a[104:107], v[160:163]
    ds_read_b64_tr_b16 v[96:97], v19 offset:24832
    ds_read_b64_tr_b16 v[98:99], v19 offset:25600
    v_mfma_f32_16x16x32_bf16 v[164:167], v[120:123], a[108:111], v[164:167]
    s_add_u32 m0, s57, 49664
    ds_read_b64_tr_b16 v[100:101], v19 offset:24880
    ds_read_b64_tr_b16 v[102:103], v19 offset:25648
    buffer_load_dwordx4 v31, s[12:15], s32 offen offset:0 sc1 lds
    v_mfma_f32_16x16x32_bf16 v[168:171], v[124:127], a[104:107], v[168:171]
    ds_read_b128 a[112:115], v14 offset:16384
    ds_read_b128 a[116:119], v14 offset:18432
    buffer_load_dwordx4 v32, s[12:15], s32 offen offset:1024 sc1 lds
    v_mfma_f32_16x16x32_bf16 v[172:175], v[124:127], a[108:111], v[172:175]
    ds_read_b64_tr_b16 v[104:105], v19 offset:24928
    ds_read_b64_tr_b16 v[106:107], v19 offset:25696
    v_mfma_f32_16x16x32_bf16 v[176:179], v[128:131], a[104:107], v[176:179]
    ds_read_b64_tr_b16 v[108:109], v19 offset:24976
    ds_read_b64_tr_b16 v[110:111], v19 offset:25744
    buffer_load_dwordx4 v33, s[12:15], s32 offen offset:2048 sc1 lds
    v_mfma_f32_16x16x32_bf16 v[180:183], v[128:131], a[108:111], v[180:183]
    s_add_u32 m0, s57, 0
    ds_read_b64_tr_b16 v[112:113], v20 offset:24832
    ds_read_b64_tr_b16 v[114:115], v20 offset:25600
    buffer_load_dwordx4 v31, s[12:15], s33 offen offset:0 sc1 lds
    v_mfma_f32_16x16x32_bf16 v[184:187], v[132:135], a[104:107], v[184:187]
    ds_read_b128 a[120:123], v15 offset:16384
    ds_read_b128 a[124:127], v15 offset:18432
    v_mfma_f32_16x16x32_bf16 v[188:191], v[132:135], a[108:111], v[188:191]
    buffer_load_dwordx4 v32, s[12:15], s33 offen offset:1024 sc1 lds
    v_mfma_f32_16x16x32_bf16 v[192:195], v[136:139], a[104:107], v[192:195]
    buffer_load_dwordx4 v33, s[12:15], s33 offen offset:2048 sc1 lds
    v_mfma_f32_16x16x32_bf16 v[196:199], v[136:139], a[108:111], v[196:199]
    ds_read_b64_tr_b16 v[64:65], v212 offset:0
    ds_read_b64_tr_b16 v[76:77], v213 offset:0
    ds_read_b64_tr_b16 v[66:67], v212 offset:192
    ds_read_b64_tr_b16 v[78:79], v213 offset:192
    ds_read_b64_tr_b16 v[68:69], v212 offset:384
    ds_read_b64_tr_b16 v[80:81], v213 offset:384
    ds_read_b64_tr_b16 v[70:71], v212 offset:576
    ds_read_b64_tr_b16 v[82:83], v213 offset:576
    ds_read_b64_tr_b16 v[72:73], v212 offset:768
    ds_read_b64_tr_b16 v[84:85], v213 offset:768
    v_mov_b32 v74, 0
    v_mov_b32 v75, 0
    v_mov_b32 v86, 0
    v_mov_b32 v87, 0
    s_waitcnt lgkmcnt(9)
    v_and_b32 v64, v214, v64
    s_waitcnt lgkmcnt(8)
    v_and_b32 v76, v214, v76
    v_and_b32 v65, v214, v65
    v_and_b32 v77, v214, v77
    s_waitcnt lgkmcnt(7)
    v_and_b32 v66, v214, v66
    s_waitcnt lgkmcnt(6)
    v_and_b32 v78, v214, v78
    v_and_b32 v67, v214, v67
    v_and_b32 v79, v214, v79
    s_waitcnt lgkmcnt(5)
    v_and_b32 v68, v214, v68
    s_waitcnt lgkmcnt(4)
    v_and_b32 v80, v214, v80
    v_and_b32 v69, v214, v69
    v_and_b32 v81, v214, v81
    s_waitcnt lgkmcnt(3)
    v_and_b32 v70, v214, v70
    s_waitcnt lgkmcnt(2)
    v_and_b32 v82, v214, v82
    v_and_b32 v71, v214, v71
    v_and_b32 v83, v214, v83
    s_waitcnt lgkmcnt(1)
    v_and_b32 v72, v214, v72
    s_waitcnt lgkmcnt(0)
    v_and_b32 v84, v214, v84
    v_and_b32 v73, v214, v73
    v_and_b32 v85, v214, v85
    v_mfma_f32_16x16x32_bf16 v[160:163], v[96:99], a[112:115], v[160:163]
    ds_read_b64_tr_b16 v[120:121], v19 offset:31040
    ds_read_b64_tr_b16 v[122:123], v19 offset:31808
    v_mfma_f32_16x16x32_bf16 v[164:167], v[96:99], a[116:119], v[164:167]
    ds_read_b64_tr_b16 v[124:125], v19 offset:31088
    ds_read_b64_tr_b16 v[126:127], v19 offset:31856
    v_mfma_f32_16x16x32_bf16 v[168:171], v[100:103], a[112:115], v[168:171]
    s_add_u32 m0, s57, 12416
    ds_read_b64_tr_b16 v[128:129], v19 offset:31136
    ds_read_b64_tr_b16 v[130:131], v19 offset:31904
    buffer_load_dwordx4 v31, s[12:15], s34 offen offset:0 sc1 lds
    v_mfma_f32_16x16x32_bf16 v[172:175], v[100:103], a[116:119], v[172:175]
    ds_read_b64_tr_b16 v[132:133], v19 offset:31184
    ds_read_b64_tr_b16 v[134:135], v19 offset:31952
    v_mfma_f32_16x16x32_bf16 v[176:179], v[104:107], a[112:115], v[176:179]
    ds_read_b64_tr_b16 v[136:137], v20 offset:31040
    ds_read_b64_tr_b16 v[138:139], v20 offset:31808
    v_mfma_f32_16x16x32_bf16 v[180:183], v[104:107], a[116:119], v[180:183]
    buffer_load_dwordx4 v32, s[12:15], s34 offen offset:1024 sc1 lds
    ds_write_b16 v21, v30 offset:37248
    v_mfma_f32_16x16x32_bf16 v[184:187], v[108:111], a[112:115], v[184:187]
    v_mfma_f32_16x16x32_bf16 v[188:191], v[108:111], a[116:119], v[188:191]
    v_mfma_f32_16x16x32_bf16 v[192:195], v[112:115], a[112:115], v[192:195]
    buffer_load_dwordx4 v33, s[12:15], s34 offen offset:2048 sc1 lds
    v_mfma_f32_16x16x32_bf16 v[196:199], v[112:115], a[116:119], v[196:199]
    s_waitcnt lgkmcnt(0)
    s_barrier
    v_mfma_f32_16x16x32_bf16 v[160:163], v[120:123], a[120:123], v[160:163]
    ds_read_b64_tr_b16 v[96:97], v19 offset:37248
    ds_read_b64_tr_b16 v[98:99], v19 offset:38016
    v_mfma_f32_16x16x32_bf16 v[164:167], v[120:123], a[124:127], v[164:167]
    ds_read_b64_tr_b16 v[100:101], v19 offset:37296
    ds_read_b64_tr_b16 v[102:103], v19 offset:38064
    v_mfma_f32_16x16x32_bf16 v[168:171], v[124:127], a[120:123], v[168:171]
    s_add_u32 m0, s57, 24832
    ds_read_b128 a[128:131], v14 offset:32768
    ds_read_b128 a[132:135], v14 offset:34816
    buffer_load_dwordx4 v31, s[12:15], s35 offen offset:0 sc1 lds
    v_mfma_f32_16x16x32_bf16 v[172:175], v[124:127], a[124:127], v[172:175]
    ds_read_b64_tr_b16 v[104:105], v19 offset:37344
    ds_read_b64_tr_b16 v[106:107], v19 offset:38112
    v_mfma_f32_16x16x32_bf16 v[176:179], v[128:131], a[120:123], v[176:179]
    ds_read_b64_tr_b16 v[108:109], v19 offset:37392
    ds_read_b64_tr_b16 v[110:111], v19 offset:38160
    v_mfma_f32_16x16x32_bf16 v[180:183], v[128:131], a[124:127], v[180:183]
    ds_read_b64_tr_b16 v[112:113], v20 offset:37248
    ds_read_b64_tr_b16 v[114:115], v20 offset:38016
    buffer_load_dwordx4 v32, s[12:15], s35 offen offset:1024 sc1 lds
    v_mfma_f32_16x16x32_bf16 v[184:187], v[132:135], a[120:123], v[184:187]
    ds_read_b128 a[136:139], v15 offset:32768
    ds_read_b128 a[140:143], v15 offset:34816
    v_mfma_f32_16x16x32_bf16 v[188:191], v[132:135], a[124:127], v[188:191]
    v_mfma_f32_16x16x32_bf16 v[192:195], v[136:139], a[120:123], v[192:195]
    buffer_load_dwordx4 v33, s[12:15], s35 offen offset:2048 sc1 lds
    v_mfma_f32_16x16x32_bf16 v[196:199], v[136:139], a[124:127], v[196:199]
    v_mul_u32_u24 v11, 320, v146
    v_lshl_add_u32 v11, v152, 4, v11
    v_lshlrev_b32 v10, 2, v152
    v_mad_i32_i24 v12, v146, -4, v152
    v_mov_b32 v13, 0xffff
    v_cmp_le_i32 s[64:65], 0, v12
    v_cmp_le_i32 s[66:67], 1, v12
    v_cmp_le_i32 s[68:69], 2, v12
    v_cmp_le_i32 s[70:71], 3, v12
    v_cmp_le_i32 s[72:73], 8, v12
    v_cmp_le_i32 s[74:75], 9, v12
    v_cmp_le_i32 s[76:77], 10, v12
    v_cmp_le_i32 s[78:79], 11, v12
    v_cmp_le_i32 s[80:81], 16, v12
    v_cmp_le_i32 s[82:83], 17, v12
    v_cmp_le_i32 s[84:85], 18, v12
    v_cmp_le_i32 s[86:87], 19, v12
    v_cmp_le_i32 s[88:89], 24, v12
    v_cmp_le_i32 s[90:91], 25, v12
    v_cmp_le_i32 s[92:93], 26, v12
    v_cmp_le_i32 s[94:95], 27, v12
    v_cndmask_b32 v2, 0, v13, s[64:65]
    v_cndmask_b32 v3, 0, v13, s[68:69]
    v_cndmask_b32 v4, 0, v13, s[72:73]
    v_cndmask_b32 v5, 0, v13, s[76:77]
    v_cndmask_b32 v6, 0, v13, s[80:81]
    v_cndmask_b32 v7, 0, v13, s[84:85]
    v_cndmask_b32 v8, 0, v13, s[88:89]
    v_cndmask_b32 v9, 0, v13, s[92:93]
    v_cndmask_b32 v2, v2, -1, s[66:67]
    v_cndmask_b32 v3, v3, -1, s[70:71]
    v_cndmask_b32 v4, v4, -1, s[74:75]
    v_cndmask_b32 v5, v5, -1, s[78:79]
    v_cndmask_b32 v6, v6, -1, s[82:83]
    v_cndmask_b32 v7, v7, -1, s[86:87]
    v_cndmask_b32 v8, v8, -1, s[90:91]
    v_cndmask_b32 v9, v9, -1, s[94:95]
    s_waitcnt lgkmcnt(0)
    v_mfma_f32_16x16x32_bf16 v[160:163], v[96:99], a[128:131], v[160:163]
    ds_read_b64_tr_b16 v[120:121], v19 offset:43456
    ds_read_b64_tr_b16 v[122:123], v19 offset:44224
    v_mfma_f32_16x16x32_bf16 v[164:167], v[96:99], a[132:135], v[164:167]
    ds_read_b64_tr_b16 v[124:125], v19 offset:43504
    ds_read_b64_tr_b16 v[126:127], v19 offset:44272
    v_mfma_f32_16x16x32_bf16 v[168:171], v[100:103], a[128:131], v[168:171]
    ds_read_b64_tr_b16 v[128:129], v19 offset:43552
    ds_read_b64_tr_b16 v[130:131], v19 offset:44320
    v_mfma_f32_16x16x32_bf16 v[172:175], v[100:103], a[132:135], v[172:175]
    ds_read_b64_tr_b16 v[132:133], v19 offset:43600
    ds_read_b64_tr_b16 v[134:135], v19 offset:44368
    v_mfma_f32_16x16x32_bf16 v[176:179], v[104:107], a[128:131], v[176:179]
    ds_read_b64_tr_b16 v[136:137], v20 offset:43456
    ds_read_b64_tr_b16 v[138:139], v20 offset:44224
    v_mfma_f32_16x16x32_bf16 v[180:183], v[104:107], a[132:135], v[180:183]
    s_waitcnt vmcnt(9)
    v_mfma_f32_16x16x32_bf16 v[184:187], v[108:111], a[128:131], v[184:187]
    v_mfma_f32_16x16x32_bf16 v[188:191], v[108:111], a[132:135], v[188:191]
    v_mfma_f32_16x16x32_bf16 v[192:195], v[112:115], a[128:131], v[192:195]
    v_mfma_f32_16x16x32_bf16 v[196:199], v[112:115], a[132:135], v[196:199]
    s_waitcnt lgkmcnt(0)
    s_barrier
    v_mfma_f32_16x16x32_bf16 v[160:163], v[120:123], a[136:139], v[160:163]
    ds_read_b128 v[96:99], v224 offset:49664
    ds_read_b128 v[100:103], v224 offset:50688
    v_mfma_f32_16x16x32_bf16 v[164:167], v[120:123], a[140:143], v[164:167]
    ds_read_b128 v[104:107], v224 offset:51712
    ds_read_b128 v[108:111], v224 offset:52736
    v_mfma_f32_16x16x32_bf16 v[168:171], v[124:127], a[136:139], v[168:171]
    s_add_u32 m0, s57, 37248
    ds_read_b128 v[112:115], v224 offset:53760
    ds_read_b128 v[116:119], v224 offset:54784
    buffer_load_dwordx4 v31, s[12:15], s36 offen offset:0 sc1 lds
    v_mfma_f32_16x16x32_bf16 v[172:175], v[124:127], a[140:143], v[172:175]
    v_mfma_f32_16x16x32_bf16 v[176:179], v[128:131], a[136:139], v[176:179]
    v_mfma_f32_16x16x32_bf16 v[180:183], v[128:131], a[140:143], v[180:183]
    buffer_load_dwordx4 v32, s[12:15], s36 offen offset:1024 sc1 lds
    v_mfma_f32_16x16x32_bf16 v[184:187], v[132:135], a[136:139], v[184:187]
    v_mfma_f32_16x16x32_bf16 v[188:191], v[132:135], a[140:143], v[188:191]
    s_waitcnt lgkmcnt(5)
    v_mfma_f32_16x16x32_bf16 v[192:195], v[136:139], a[136:139], v[192:195]
    buffer_load_dwordx4 v33, s[12:15], s36 offen offset:2048 sc1 lds
    v_mfma_f32_16x16x32_bf16 v[196:199], v[136:139], a[140:143], v[196:199]
    v_mfma_f32_16x16x32_bf16 v[40:43], v[96:99], a[0:3], 0
    ds_read_b128 v[120:123], v224 offset:55808
    v_and_b32 v226, 16, v0
    v_cmp_eq_u32 vcc, 0, v226
    v_accvgpr_write_b32 a208, -1
    v_accvgpr_write_b32 a209, -1
    v_accvgpr_write_b32 a210, -1
    v_accvgpr_write_b32 a211, -1
    v_mfma_f32_16x16x32_bf16 v[44:47], v[96:99], a[4:7], 0
    s_add_u32 s62, s16, 0
    ds_read_b128 v[124:127], v224 offset:56832
    buffer_store_dwordx4 a[208:211], v240, s[20:23], s62 offen sc1
    s_mul_i32 s63, s31, 0x3f80
    s_waitcnt lgkmcnt(6)
    v_mfma_f32_16x16x32_bf16 v[48:51], v[100:103], a[0:3], 0
    s_add_u32 s62, s16, 2048
    ds_read_b128 v[128:131], v224 offset:57856
    v_cvt_pk_bf16_f32 v160, v160, v161
    v_cvt_pk_bf16_f32 v161, v162, v163
    v_mfma_f32_16x16x32_bf16 v[52:55], v[100:103], a[4:7], 0
    s_waitcnt lgkmcnt(6)
    ds_read_b128 v[132:135], v224 offset:58880
    ds_write_b64 v35, v[160:161] offset:0
    buffer_store_dwordx4 a[208:211], v240, s[20:23], s62 offen sc1
    v_mfma_f32_16x16x32_bf16 v[56:59], v[104:107], a[0:3], 0
    s_add_u32 s62, s16, 4096
    ds_read_b128 v[136:139], v224 offset:59904
    v_cvt_pk_bf16_f32 v164, v164, v165
    v_cvt_pk_bf16_f32 v165, v166, v167
    v_mfma_f32_16x16x32_bf16 v[60:63], v[104:107], a[4:7], 0
    s_waitcnt lgkmcnt(7)
    ds_read_b128 v[140:143], v224 offset:60928
    ds_write_b64 v35, v[164:165] offset:256
    v_mfma_f32_16x16x32_bf16 v[40:43], v[108:111], a[8:11], v[40:43]
    buffer_store_dwordx4 a[208:211], v240, s[20:23], s62 offen sc1
    v_cvt_pk_bf16_f32 v168, v168, v169
    v_cvt_pk_bf16_f32 v169, v170, v171
    v_mfma_f32_16x16x32_bf16 v[44:47], v[108:111], a[12:15], v[44:47]
    s_add_u32 s62, s16, 6144
    ds_write_b64 v35, v[168:169] offset:1280
    v_mfma_f32_16x16x32_bf16 v[48:51], v[112:115], a[8:11], v[48:51]
    s_waitcnt lgkmcnt(9)
    v_cvt_pk_bf16_f32 v172, v172, v173
    v_cvt_pk_bf16_f32 v173, v174, v175
    v_mfma_f32_16x16x32_bf16 v[52:55], v[112:115], a[12:15], v[52:55]
    buffer_store_dwordx4 a[208:211], v240, s[20:23], s62 offen sc1
    ds_write_b64 v35, v[172:173] offset:1536
    v_mfma_f32_16x16x32_bf16 v[56:59], v[116:119], a[8:11], v[56:59]
    s_mov_b32 exec_hi, 0
    buffer_store_dwordx4 a[208:211], v241, s[20:23], s17 offen sc1
    s_mov_b32 exec_hi, -1
    v_cvt_pk_bf16_f32 v176, v176, v177
    v_cvt_pk_bf16_f32 v177, v178, v179
    v_mfma_f32_16x16x32_bf16 v[60:63], v[116:119], a[12:15], v[60:63]
    ds_write_b64 v35, v[176:177] offset:2560
    s_waitcnt vmcnt(14)
    s_barrier
    s_waitcnt lgkmcnt(10)
    v_mfma_f32_16x16x32_bf16 v[40:43], v[120:123], a[16:19], v[40:43]
    s_waitcnt lgkmcnt(9)
    ds_read_b128 v[96:99], v224 offset:0
    v_cvt_pk_bf16_f32 v180, v180, v181
    v_cvt_pk_bf16_f32 v181, v182, v183
    v_mfma_f32_16x16x32_bf16 v[44:47], v[120:123], a[20:23], v[44:47]
    s_waitcnt lgkmcnt(9)
    ds_read_b128 v[100:103], v224 offset:1024
    ds_write_b64 v35, v[180:181] offset:2816
    v_mfma_f32_16x16x32_bf16 v[48:51], v[124:127], a[16:19], v[48:51]
    ds_read_b128 v[104:107], v224 offset:2048
    v_cvt_pk_bf16_f32 v184, v184, v185
    v_cvt_pk_bf16_f32 v185, v186, v187
    v_mfma_f32_16x16x32_bf16 v[52:55], v[124:127], a[20:23], v[52:55]
    s_waitcnt lgkmcnt(11)
    ds_read_b128 v[108:111], v224 offset:3072
    ds_write_b64 v35, v[184:185] offset:3840
    v_mfma_f32_16x16x32_bf16 v[56:59], v[128:131], a[16:19], v[56:59]
    ds_read_b128 v[112:115], v224 offset:4096
    v_cvt_pk_bf16_f32 v188, v188, v189
    v_cvt_pk_bf16_f32 v189, v190, v191
    v_mfma_f32_16x16x32_bf16 v[60:63], v[128:131], a[20:23], v[60:63]
    s_waitcnt lgkmcnt(12)
    ds_read_b128 v[116:119], v224 offset:5120
    ds_write_b64 v35, v[188:189] offset:4096
    v_mfma_f32_16x16x32_bf16 v[40:43], v[132:135], a[24:27], v[40:43]
    v_cvt_pk_bf16_f32 v194, v194, v195
    v_mov_b32 v195, s63
    v_mfma_f32_16x16x32_bf16 v[44:47], v[132:135], a[28:31], v[44:47]
    s_waitcnt lgkmcnt(13)
    ds_write_b64 v36, v[194:195] offset:0
    v_mfma_f32_16x16x32_bf16 v[48:51], v[136:139], a[24:27], v[48:51]
    v_cvt_pk_bf16_f32 v198, v198, v199
    v_mov_b32 v199, s63
    v_mfma_f32_16x16x32_bf16 v[52:55], v[136:139], a[28:31], v[52:55]
    s_waitcnt lgkmcnt(9)
    ds_write_b64 v36, v[198:199] offset:128
    v_mfma_f32_16x16x32_bf16 v[56:59], v[140:143], a[24:27], v[56:59]
    ds_read_b128 v[160:163], v37 offset:0
    ds_read_b128 v[164:167], v37 offset:1024
    v_mfma_f32_16x16x32_bf16 v[60:63], v[140:143], a[28:31], v[60:63]
    s_waitcnt lgkmcnt(11)
    ds_read_b128 v[168:171], v37 offset:2048
    ds_read_b128 v[120:123], v224 offset:6144
    v_mfma_f32_16x16x32_bf16 v[40:43], v[96:99], a[32:35], v[40:43]
    ds_read_b128 v[172:175], v37 offset:3072
    ds_read_b128 v[176:179], v37 offset:4096
    v_mfma_f32_16x16x32_bf16 v[44:47], v[96:99], a[36:39], v[44:47]
    s_waitcnt lgkmcnt(13)
    ds_read_b128 v[124:127], v224 offset:7168
    v_cndmask_b32 v226, v196, v192, vcc
    v_mfma_f32_16x16x32_bf16 v[48:51], v[100:103], a[32:35], v[48:51]
    ds_read_b128 v[128:131], v224 offset:8192
    v_mul_f32 v226, 0xbfb8aa3b, v226
    v_exp_f32 v226, v226
    v_mfma_f32_16x16x32_bf16 v[52:55], v[100:103], a[36:39], v[52:55]
    s_waitcnt lgkmcnt(14)
    ds_read_b128 v[132:135], v224 offset:9216
    v_add_f32 v226, 1.0, v226
    v_mfma_f32_16x16x32_bf16 v[56:59], v[104:107], a[32:35], v[56:59]
    s_mul_i32 s63, s31, 2621440
    ds_read_b128 v[136:139], v224 offset:10240
    v_rcp_f32 v225, v226
    v_mfma_f32_16x16x32_bf16 v[60:63], v[104:107], a[36:39], v[60:63]
    s_mul_i32 s3, s30, 327680
    v_sub_f32 v226, 1.0, v225
    s_add_u32 s63, s63, s3
    v_mfma_f32_16x16x32_bf16 v[40:43], v[108:111], a[40:43], v[40:43]
    s_lshl_b32 s3, s29, 2
    ds_read_b128 v[140:143], v224 offset:11264
    s_add_u32 s3, s3, s28
    v_mfma_f32_16x16x32_bf16 v[44:47], v[108:111], a[44:47], v[44:47]
    s_mul_i32 s3, s3, 2560
    s_add_u32 s63, s63, s3
    s_add_u32 s63, s63, 1048576
    s_waitcnt lgkmcnt(15)
    v_mfma_f32_16x16x32_bf16 v[48:51], v[112:115], a[40:43], v[48:51]
    s_add_u32 s3, s63, 164352
    s_waitcnt vmcnt(11)
    v_mfma_f32_16x16x32_bf16 v[52:55], v[112:115], a[44:47], v[52:55]
    s_waitcnt lgkmcnt(14)
    s_barrier
    v_mfma_f32_16x16x32_bf16 v[56:59], v[116:119], a[40:43], v[56:59]
    s_add_u32 s4, s16, 4096
    ds_read_b128 v[96:99], v224 offset:12416
    v_bfe_u32 v204, v0, 3, 2
    v_mfma_f32_16x16x32_bf16 v[60:63], v[116:119], a[44:47], v[60:63]
    s_lshl2_add_u32 s47, s98, s28
    ds_read_b128 v[100:103], v224 offset:13440
    v_bfe_u32 v205, v0, 1, 1
    s_waitcnt lgkmcnt(9)
    v_mfma_f32_16x16x32_bf16 v[40:43], v[120:123], a[48:51], v[40:43]
    s_add_u32 m0, s57, 49664
    ds_read_b128 v[104:107], v224 offset:14464
    buffer_load_dwordx4 v34, s[12:15], s37 offen offset:0 sc1 lds
    v_mfma_f32_16x16x32_bf16 v[44:47], v[120:123], a[52:55], v[44:47]
    s_mul_i32 s6, s47, 12288
    v_lshl_add_u32 v204, v204, 1, v205
    s_waitcnt lgkmcnt(7)
    v_mfma_f32_16x16x32_bf16 v[48:51], v[124:127], a[48:51], v[48:51]
    s_add_u32 s6, s6, 9043968
    ds_read_b128 v[108:111], v224 offset:15488
    ds_read_b128 v[112:115], v224 offset:16512
    v_mfma_f32_16x16x32_bf16 v[52:55], v[124:127], a[52:55], v[52:55]
    s_mul_i32 s47, s29, 768
    v_and_b32 v205, 1, v0
    v_lshlrev_b32 v205, 4, v205
    s_waitcnt lgkmcnt(8)
    v_mfma_f32_16x16x32_bf16 v[56:59], v[128:131], a[48:51], v[56:59]
    s_add_u32 m0, s57, 49664
    ds_read_b128 v[116:119], v224 offset:17536
    buffer_load_dwordx4 v34, s[12:15], s38 offen offset:1024 sc1 lds
    v_mfma_f32_16x16x32_bf16 v[60:63], v[128:131], a[52:55], v[60:63]
    s_add_u32 s5, s6, s47
    v_lshlrev_b32 v205, v205, v239
    s_mul_i32 s11, s28, 9216
    s_waitcnt lgkmcnt(8)
    v_mfma_f32_16x16x32_bf16 v[40:43], v[132:135], a[56:59], v[40:43]
    s_add_u32 s11, s11, 11206656
    v_bfe_u32 v206, v0, 2, 1
    v_bfe_u32 v207, v0, 5, 1
    v_mfma_f32_16x16x32_bf16 v[44:47], v[132:135], a[60:63], v[44:47]
    s_xor_b32 s47, s28, 0
    v_cmp_eq_u32 vcc, v206, v207
    s_waitcnt lgkmcnt(7)
    v_mfma_f32_16x16x32_bf16 v[48:51], v[136:139], a[56:59], v[48:51]
    s_lshl2_add_u32 s47, s97, s47
    ds_read_b128 v[120:123], v224 offset:18560
    v_mfma_f32_16x16x32_bf16 v[52:55], v[136:139], a[60:63], v[52:55]
    s_mul_i32 s47, s47, 36864
    v_cndmask_b32 v205, 0, v205, vcc
    s_waitcnt lgkmcnt(7)
    v_mfma_f32_16x16x32_bf16 v[56:59], v[140:143], a[56:59], v[56:59]
    s_waitcnt lgkmcnt(6)
    buffer_store_dwordx4 v[160:163], v224, s[20:23], s63 offen offset:0 sc1
    v_mfma_f32_16x16x32_bf16 v[60:63], v[140:143], a[60:63], v[60:63]
    s_add_u32 s7, s47, s11
    ds_read_b128 v[124:127], v224 offset:19584
    v_cmp_eq_u32 vcc, 0, v204
    v_mfma_f32_16x16x32_bf16 v[40:43], v[96:99], a[64:67], v[40:43]
    s_add_u32 m0, s57, 49664
    ds_read_b128 v[128:131], v224 offset:20608
    v_mfma_f32_16x16x32_bf16 v[44:47], v[96:99], a[68:71], v[44:47]
    s_xor_b32 s47, s28, 1
    buffer_load_dwordx4 v34, s[12:15], s39 offen offset:2048 sc1 lds
    v_cndmask_b32 v200, 0, v205, vcc
    s_waitcnt lgkmcnt(7)
    v_mfma_f32_16x16x32_bf16 v[48:51], v[100:103], a[64:67], v[48:51]
    s_lshl2_add_u32 s47, s97, s47
    ds_read_b128 v[132:135], v224 offset:21632
    ds_read_b128 v[136:139], v224 offset:22656
    v_mfma_f32_16x16x32_bf16 v[52:55], v[100:103], a[68:71], v[52:55]
    s_mul_i32 s47, s47, 36864
    v_cmp_eq_u32 vcc, 1, v204
    s_waitcnt lgkmcnt(8)
    v_mfma_f32_16x16x32_bf16 v[56:59], v[104:107], a[64:67], v[56:59]
    s_add_u32 s8, s47, s11
    ds_read_b128 v[140:143], v224 offset:23680
    v_cndmask_b32 v201, 0, v205, vcc
    v_mfma_f32_16x16x32_bf16 v[60:63], v[104:107], a[68:71], v[60:63]
    s_xor_b32 s47, s28, 2
    v_cmp_eq_u32 vcc, 2, v204
    s_waitcnt lgkmcnt(8)
    v_mfma_f32_16x16x32_bf16 v[40:43], v[108:111], a[72:75], v[40:43]
    s_waitcnt lgkmcnt(7)
    buffer_store_dwordx4 v[164:167], v224, s[20:23], s63 offen offset:1024 sc1
    v_mfma_f32_16x16x32_bf16 v[44:47], v[108:111], a[76:79], v[44:47]
    s_lshl2_add_u32 s47, s97, s47
    v_cndmask_b32 v202, 0, v205, vcc
    v_cmp_eq_u32 vcc, 3, v204
    v_mfma_f32_16x16x32_bf16 v[48:51], v[112:115], a[72:75], v[48:51]
    s_mul_i32 s47, s47, 36864
    v_cndmask_b32 v203, 0, v205, vcc
    v_mfma_f32_16x16x32_bf16 v[52:55], v[112:115], a[76:79], v[52:55]
    s_add_u32 s9, s47, s11
    v_add_u32 v204, 162432, v224
    s_waitcnt lgkmcnt(6)
    v_mfma_f32_16x16x32_bf16 v[56:59], v[116:119], a[72:75], v[56:59]
    buffer_store_dwordx4 v[168:171], v38, s[20:23], s63 offen offset:2048 sc1
    v_mfma_f32_16x16x32_bf16 v[60:63], v[116:119], a[76:79], v[60:63]
    s_waitcnt vmcnt(14)
    s_barrier
    s_waitcnt lgkmcnt(5)
    v_mfma_f32_16x16x32_bf16 v[40:43], v[120:123], a[80:83], v[40:43]
    s_xor_b32 s47, s28, 3
    ds_read_b128 v[96:99], v224 offset:24832
    ds_read_b128 v[100:103], v224 offset:25856
    v_mfma_f32_16x16x32_bf16 v[44:47], v[120:123], a[84:87], v[44:47]
    s_add_u32 m0, s57, 0
    ds_write_b128 v204, v[200:203]
    s_waitcnt lgkmcnt(7)
    v_mfma_f32_16x16x32_bf16 v[48:51], v[124:127], a[80:83], v[48:51]
    s_lshl2_add_u32 s47, s97, s47
    ds_read_b128 v[104:107], v224 offset:26880
    buffer_load_dwordx4 v34, s[12:15], s40 offen offset:0 sc1 lds
    v_mfma_f32_16x16x32_bf16 v[52:55], v[124:127], a[84:87], v[52:55]
    s_mul_i32 s47, s47, 36864
    ds_read_b128 v[108:111], v224 offset:27904
    v_mov_b32 v18, 0
    s_waitcnt lgkmcnt(8)
    v_mfma_f32_16x16x32_bf16 v[56:59], v[128:131], a[80:83], v[56:59]
    s_add_u32 s10, s47, s11
    ds_read_b128 v[112:115], v224 offset:28928
    v_mov_b32 v19, 0
    v_mfma_f32_16x16x32_bf16 v[60:63], v[128:131], a[84:87], v[60:63]
    s_add_u32 m0, s57, 0
    ds_read_b128 v[116:119], v224 offset:29952
    v_mov_b32 v22, 0
    s_waitcnt lgkmcnt(9)
    v_mfma_f32_16x16x32_bf16 v[40:43], v[132:135], a[88:91], v[40:43]
    s_and_b32 s47, s28, 2
    buffer_load_dwordx4 v34, s[12:15], s41 offen offset:1024 sc1 lds
    v_mov_b32 v23, 0
    v_mfma_f32_16x16x32_bf16 v[44:47], v[132:135], a[92:95], v[44:47]
    s_add_u32 s47, s47, s28
    v_mov_b32 v26, 0
    s_lshl_b32 s47, s47, 10
    s_waitcnt lgkmcnt(8)
    v_mfma_f32_16x16x32_bf16 v[48:51], v[136:139], a[88:91], v[48:51]
    s_add_u32 s11, s47, 156288
    v_mov_b32 v27, 0
    v_mfma_f32_16x16x32_bf16 v[52:55], v[136:139], a[92:95], v[52:55]
    s_add_u32 m0, s57, 0
    ds_read_b128 v[120:123], v224 offset:30976
    s_waitcnt lgkmcnt(8)
    v_mfma_f32_16x16x32_bf16 v[56:59], v[140:143], a[88:91], v[56:59]
    s_waitcnt lgkmcnt(7)
    buffer_store_dwordx4 v[172:175], v224, s[20:23], s3 offen offset:0 sc1
    v_mfma_f32_16x16x32_bf16 v[60:63], v[140:143], a[92:95], v[60:63]
    s_waitcnt lgkmcnt(6)
    ds_read_b128 v[124:127], v224 offset:32000
    ds_read_b128 v[128:131], v224 offset:33024
    v_mfma_f32_16x16x32_bf16 v[40:43], v[96:99], a[96:99], v[40:43]
    ds_read_b128 v[132:135], v224 offset:34048
    v_mfma_f32_16x16x32_bf16 v[44:47], v[96:99], a[100:103], v[44:47]
    s_waitcnt lgkmcnt(7)
    buffer_load_dwordx4 v34, s[12:15], s42 offen offset:2048 sc1 lds
    ds_read_b128 v[136:139], v224 offset:35072
    v_mfma_f32_16x16x32_bf16 v[48:51], v[100:103], a[96:99], v[48:51]
    ds_read_b128 v[140:143], v224 offset:36096
    v_mfma_f32_16x16x32_bf16 v[52:55], v[100:103], a[100:103], v[52:55]
    s_lshr_b32 s62, s28, 1
    v_mfma_f32_16x16x32_bf16 v[56:59], v[104:107], a[96:99], v[56:59]
    s_mul_i32 s62, s62, 2621440
    v_mfma_f32_16x16x32_bf16 v[60:63], v[104:107], a[100:103], v[60:63]
    s_add_u32 m0, s57, 12416
    s_waitcnt lgkmcnt(8)
    v_mfma_f32_16x16x32_bf16 v[40:43], v[108:111], a[104:107], v[40:43]
    s_mul_i32 s63, s98, 163840
    v_mfma_f32_16x16x32_bf16 v[44:47], v[108:111], a[108:111], v[44:47]
    s_add_u32 s62, s62, s63
    s_waitcnt lgkmcnt(7)
    v_mfma_f32_16x16x32_bf16 v[48:51], v[112:115], a[104:107], v[48:51]
    s_waitcnt lgkmcnt(6)
    v_mfma_f32_16x16x32_bf16 v[52:55], v[112:115], a[108:111], v[52:55]
    buffer_store_dwordx4 v[176:179], v224, s[20:23], s3 offen offset:1024 sc1
    v_mfma_f32_16x16x32_bf16 v[56:59], v[116:119], a[104:107], v[56:59]
    s_waitcnt vmcnt(16)
    s_barrier
    v_mfma_f32_16x16x32_bf16 v[60:63], v[116:119], a[108:111], v[60:63]
    s_waitcnt lgkmcnt(4)
    ds_read_b128 v[96:99], v224 offset:37248
    ds_read_b128 v[100:103], v224 offset:38272
    v_mfma_f32_16x16x32_bf16 v[40:43], v[120:123], a[112:115], v[40:43]
    ds_read_b128 v[104:107], v224 offset:39296
    buffer_load_dwordx4 v34, s[12:15], s43 offen offset:0 sc1 lds
    v_mfma_f32_16x16x32_bf16 v[44:47], v[120:123], a[116:119], v[44:47]
    s_add_u32 s62, s62, 1028096
    s_add_u32 m0, s57, 12416
    v_mfma_f32_16x16x32_bf16 v[48:51], v[124:127], a[112:115], v[48:51]
    s_and_b32 s63, s28, 1
    v_mfma_f32_16x16x32_bf16 v[52:55], v[124:127], a[116:119], v[52:55]
    s_mul_i32 s63, s63, 6
    ds_read_b128 v[120:123], v224 offset:40320
    s_waitcnt lgkmcnt(7)
    v_mfma_f32_16x16x32_bf16 v[56:59], v[128:131], a[112:115], v[56:59]
    s_waitcnt lgkmcnt(6)
    buffer_load_dwordx4 v34, s[12:15], s44 offen offset:1024 sc1 lds
    v_mfma_f32_16x16x32_bf16 v[60:63], v[128:131], a[116:119], v[60:63]
    s_lshl_b32 s3, s29, 2
    ds_read_b128 v[124:127], v224 offset:41344
    v_mfma_f32_16x16x32_bf16 v[40:43], v[132:135], a[120:123], v[40:43]
    s_add_u32 s99, s63, s3
    v_mfma_f32_16x16x32_bf16 v[44:47], v[132:135], a[124:127], v[44:47]
    s_add_u32 m0, s57, 12416
    ds_read_b128 v[128:131], v224 offset:42368
    s_waitcnt lgkmcnt(7)
    v_mfma_f32_16x16x32_bf16 v[48:51], v[136:139], a[120:123], v[48:51]
    s_mul_i32 s63, s99, 2560
    v_mfma_f32_16x16x32_bf16 v[52:55], v[136:139], a[124:127], v[52:55]
    s_add_u32 s62, s62, s63
    buffer_load_dwordx4 v34, s[12:15], s45 offen offset:2048 sc1 lds
    s_waitcnt lgkmcnt(6)
    v_mfma_f32_16x16x32_bf16 v[56:59], v[140:143], a[120:123], v[56:59]
    s_waitcnt vmcnt(10)
    v_add_u32 v34, 82944, v34
    v_mfma_f32_16x16x32_bf16 v[60:63], v[140:143], a[124:127], v[60:63]
    s_waitcnt lgkmcnt(3)
    v_mfma_f32_16x16x32_bf16 v[40:43], v[96:99], a[128:131], v[40:43]
    s_barrier
    v_mfma_f32_16x16x32_bf16 v[44:47], v[96:99], a[132:135], v[44:47]
    s_add_u32 s24, s52, s62
    ds_read_b128 v[96:99], v224 offset:49664
    v_mfma_f32_16x16x32_bf16 v[48:51], v[100:103], a[128:131], v[48:51]
    s_addc_u32 s25, s53, 0
    v_mfma_f32_16x16x32_bf16 v[52:55], v[100:103], a[132:135], v[52:55]
    s_add_u32 m0, s57, 24832
    ds_read_b128 v[100:103], v224 offset:52736
    v_mfma_f32_16x16x32_bf16 v[56:59], v[104:107], a[128:131], v[56:59]
    s_mov_b32 s26, 15360
    buffer_load_dwordx4 v34, s[12:15], s37 offen offset:0 sc1 lds
    v_mfma_f32_16x16x32_bf16 v[60:63], v[104:107], a[132:135], v[60:63]
    s_mov_b32 s27, 0x20000
    ds_read_b128 v[104:107], v224 offset:50688
    s_waitcnt lgkmcnt(5)
    v_mfma_f32_16x16x32_bf16 v[40:43], v[120:123], a[136:139], v[40:43]
    s_mul_i32 s55, s28, 15360
    ds_read_b128 v[108:111], v224 offset:53760
    v_mfma_f32_16x16x32_bf16 v[44:47], v[120:123], a[140:143], v[44:47]
    s_add_u32 m0, s57, 24832
    ds_read_b128 v[112:115], v224 offset:51712
    s_waitcnt lgkmcnt(6)
    v_mfma_f32_16x16x32_bf16 v[48:51], v[124:127], a[136:139], v[48:51]
    s_add_u32 s55, s55, 62080
    buffer_load_dwordx4 v34, s[12:15], s38 offen offset:1024 sc1 lds
    v_mfma_f32_16x16x32_bf16 v[52:55], v[124:127], a[140:143], v[52:55]
    s_waitcnt lgkmcnt(4)
    ds_read_b128 v[116:119], v224 offset:54784
    v_mfma_f32_16x16x32_bf16 v[56:59], v[128:131], a[136:139], v[56:59]
    ds_read_b128 v[120:123], v224 offset:55808
    v_cvt_pk_bf16_f32 v40, v40, v41
    v_mfma_f32_16x16x32_bf16 v[60:63], v[128:131], a[140:143], v[60:63]
    s_waitcnt lgkmcnt(5)
    v_cvt_pk_bf16_f32 v41, v42, v43
    v_cvt_pk_bf16_f32 v44, v44, v45
    v_mfma_f32_16x16x32_bf16 v[144:147], v[96:99], a[0:3], 0
    ds_write_b64 v35, v[40:41] offset:0
    v_mfma_f32_16x16x32_bf16 v[148:151], v[96:99], a[4:7], 0
    ds_read_b128 v[124:127], v224 offset:58880
    v_cvt_pk_bf16_f32 v45, v46, v47
    v_cvt_pk_bf16_f32 v48, v48, v49
    v_mfma_f32_16x16x32_bf16 v[152:155], v[100:103], a[0:3], 0
    s_waitcnt lgkmcnt(6)
    ds_write_b64 v35, v[44:45] offset:256
    ds_read_b128 v[128:131], v224 offset:56832
    v_cvt_pk_bf16_f32 v49, v50, v51
    v_cvt_pk_bf16_f32 v52, v52, v53
    v_mfma_f32_16x16x32_bf16 v[156:159], v[100:103], a[4:7], 0
    ds_write_b64 v35, v[48:49] offset:1280
    ds_read_b128 v[132:135], v224 offset:59904
    v_cvt_pk_bf16_f32 v53, v54, v55
    v_mul_f32 v56, v56, v218
    v_mfma_f32_16x16x32_bf16 v[144:147], v[104:107], a[8:11], v[144:147]
    s_waitcnt lgkmcnt(9)
    ds_write_b64 v35, v[52:53] offset:1536
    ds_read_b128 v[136:139], v224 offset:57856
    v_mul_f32 v57, v57, v218
    v_cvt_pk_bf16_f32 v56, v56, v57
    v_mul_f32 v58, v58, v218
    v_mfma_f32_16x16x32_bf16 v[148:151], v[104:107], a[12:15], v[148:151]
    ds_write2_b32 v216, v56, v239 offset0:0 offset1:1
    ds_read_b128 v[140:143], v224 offset:60928
    v_mul_f32 v59, v59, v218
    v_cvt_pk_bf16_f32 v58, v58, v59
    v_mfma_f32_16x16x32_bf16 v[152:155], v[108:111], a[8:11], v[152:155]
    s_add_u32 m0, s57, 24832
    ds_write2_b32 v217, v58, v239 offset0:0 offset1:1
    buffer_load_dwordx4 v34, s[12:15], s39 offen offset:2048 sc1 lds
    v_mul_f32 v60, v60, v218
    v_mul_f32 v61, v61, v218
    v_cvt_pk_bf16_f32 v60, v60, v61
    v_mfma_f32_16x16x32_bf16 v[156:159], v[108:111], a[12:15], v[156:159]
    s_waitcnt lgkmcnt(13)
    ds_write2_b32 v216, v60, v239 offset0:32 offset1:33
    v_mul_f32 v62, v62, v218
    v_mul_f32 v63, v63, v218
    v_mfma_f32_16x16x32_bf16 v[144:147], v[112:115], a[16:19], v[144:147]
    s_waitcnt lgkmcnt(13)
    v_cvt_pk_bf16_f32 v62, v62, v63
    v_mov_b32 v202, 0
    v_mfma_f32_16x16x32_bf16 v[148:151], v[112:115], a[20:23], v[148:151]
    ds_write2_b32 v217, v62, v239 offset0:32 offset1:33
    ds_read_b128 v[192:195], v231
    ds_read_b128 v[196:199], v232
    ds_read_b64 v[200:201], v233
    v_mov_b32 v203, 0
    v_mfma_f32_16x16x32_bf16 v[152:155], v[116:119], a[16:19], v[152:155]
    s_waitcnt vmcnt(7)
    s_barrier
    v_mfma_f32_16x16x32_bf16 v[156:159], v[116:119], a[20:23], v[156:159]
    s_mov_b32 s62, 393216
    ds_read_b128 v[96:99], v224 offset:0
    s_waitcnt vmcnt(6)
    s_waitcnt lgkmcnt(15)
    v_mfma_f32_16x16x32_bf16 v[144:147], v[120:123], a[24:27], v[144:147]
    buffer_store_dwordx2 v[246:247], v1, s[20:23], s62 offen sc1
    v_mfma_f32_16x16x32_bf16 v[148:151], v[120:123], a[28:31], v[148:151]
    s_waitcnt lgkmcnt(13)
    ds_read_b128 v[100:103], v224 offset:3072
    ds_read_b128 v[104:107], v224 offset:1024
    v_mfma_f32_16x16x32_bf16 v[152:155], v[124:127], a[24:27], v[152:155]
    s_add_u32 m0, s57, 37248
    ds_read_b128 v[108:111], v224 offset:4096
    buffer_load_dwordx4 v34, s[12:15], s40 offen offset:0 sc1 lds
    v_mfma_f32_16x16x32_bf16 v[156:159], v[124:127], a[28:31], v[156:159]
    s_waitcnt lgkmcnt(6)
    ds_read_b128 v[112:115], v224 offset:2048
    ds_read_b128 v[116:119], v224 offset:5120
    v_mfma_f32_16x16x32_bf16 v[144:147], v[128:131], a[32:35], v[144:147]
    s_waitcnt lgkmcnt(7)
    v_mfma_f32_32x32x16_bf16 v[176:191], v[64:67], v[192:195], 0
    s_add_u32 m0, s57, 37248
    v_mfma_f32_32x32x16_bf16 v[160:175], v[76:79], v[192:195], 0
    s_waitcnt lgkmcnt(6)
    v_mfma_f32_32x32x16_bf16 v[176:191], v[68:71], v[196:199], v[176:191]
    buffer_load_dwordx4 v34, s[12:15], s41 offen offset:1024 sc1 lds
    v_mfma_f32_32x32x16_bf16 v[160:175], v[80:83], v[196:199], v[160:175]
    v_mfma_f32_32x32x16_bf16 v[176:191], v[72:75], v[200:203], v[176:191]
    v_mfma_f32_32x32x16_bf16 v[160:175], v[84:87], v[200:203], v[160:175]
    v_mfma_f32_16x16x32_bf16 v[148:151], v[128:131], a[36:39], v[148:151]
    v_mfma_f32_16x16x32_bf16 v[152:155], v[132:135], a[32:35], v[152:155]
    v_mfma_f32_16x16x32_bf16 v[156:159], v[132:135], a[36:39], v[156:159]
    ds_read_b128 v[120:123], v224 offset:6144
    v_mfma_f32_16x16x32_bf16 v[144:147], v[136:139], a[40:43], v[144:147]
    s_nop 5
    v_max3_f32 v210, v176, v177, v178
    v_mfma_f32_16x16x32_bf16 v[148:151], v[136:139], a[44:47], v[148:151]
    v_min3_f32 v211, v176, v177, v178
    v_max3_f32 v210, v210, v179, v180
    v_min3_f32 v211, v211, v179, v180
    v_max3_f32 v210, v210, v181, v182
    v_min3_f32 v211, v211, v181, v182
    v_max3_f32 v210, v210, v183, v184
    v_min3_f32 v211, v211, v183, v184
    v_max3_f32 v210, v210, v185, v186
    v_min3_f32 v211, v211, v185, v186
    v_max3_f32 v210, v210, v187, v188
    v_min3_f32 v211, v211, v187, v188
    v_max3_f32 v210, v210, v189, v190
    v_min3_f32 v211, v211, v189, v190
    v_max3_f32 v210, v210, v191, v162
    v_min3_f32 v211, v211, v191, v162
    v_max_f32 v210, v210, v163
    v_min_f32 v211, v211, v163
    v_mul_f32 v160, s46, v211
    v_mul_f32 v210, s46, v210
    v_mfma_f32_16x16x32_bf16 v[152:155], v[140:143], a[40:43], v[152:155]
    s_waitcnt lgkmcnt(6)
    v_fma_f32 v192, -v176, s46, v160
    v_fma_f32 v193, -v177, s46, v160
    v_mfma_f32_16x16x32_bf16 v[156:159], v[140:143], a[44:47], v[156:159]
    s_waitcnt lgkmcnt(5)
    v_fma_f32 v176, v176, s46, -v210
    v_fma_f32 v177, v177, s46, -v210
    v_mfma_f32_16x16x32_bf16 v[144:147], v[96:99], a[48:51], v[144:147]
    v_fma_f32 v194, -v178, s46, v160
    v_fma_f32 v195, -v179, s46, v160
    v_mfma_f32_16x16x32_bf16 v[148:151], v[96:99], a[52:55], v[148:151]
    ds_read_b128 v[124:127], v224 offset:9216
    v_fma_f32 v178, v178, s46, -v210
    v_fma_f32 v179, v179, s46, -v210
    v_mfma_f32_16x16x32_bf16 v[152:155], v[100:103], a[48:51], v[152:155]
    s_waitcnt lgkmcnt(5)
    ds_read_b128 v[128:131], v224 offset:7168
    v_fma_f32 v196, -v180, s46, v160
    v_fma_f32 v197, -v181, s46, v160
    v_mfma_f32_16x16x32_bf16 v[156:159], v[100:103], a[52:55], v[156:159]
    ds_read_b128 v[132:135], v224 offset:10240
    v_fma_f32 v180, v180, s46, -v210
    v_fma_f32 v181, v181, s46, -v210
    v_mfma_f32_16x16x32_bf16 v[144:147], v[104:107], a[56:59], v[144:147]
    s_waitcnt lgkmcnt(6)
    ds_read_b128 v[136:139], v224 offset:8192
    v_fma_f32 v198, -v182, s46, v160
    v_fma_f32 v199, -v183, s46, v160
    v_mfma_f32_16x16x32_bf16 v[148:151], v[104:107], a[60:63], v[148:151]
    s_add_u32 m0, s57, 37248
    ds_read_b128 v[140:143], v224 offset:11264
    v_fma_f32 v182, v182, s46, -v210
    v_fma_f32 v183, v183, s46, -v210
    v_mfma_f32_16x16x32_bf16 v[152:155], v[108:111], a[56:59], v[152:155]
    s_waitcnt lgkmcnt(7)
    buffer_load_dwordx4 v34, s[12:15], s42 offen offset:2048 sc1 lds
    v_fma_f32 v200, -v184, s46, v160
    v_fma_f32 v201, -v185, s46, v160
    v_mfma_f32_16x16x32_bf16 v[156:159], v[108:111], a[60:63], v[156:159]
    v_fma_f32 v184, v184, s46, -v210
    v_fma_f32 v185, v185, s46, -v210
    v_mfma_f32_16x16x32_bf16 v[144:147], v[112:115], a[64:67], v[144:147]
    v_fma_f32 v202, -v186, s46, v160
    v_fma_f32 v203, -v187, s46, v160
    v_mfma_f32_16x16x32_bf16 v[148:151], v[112:115], a[68:71], v[148:151]
    s_waitcnt vmcnt(7)
    v_fma_f32 v186, v186, s46, -v210
    v_fma_f32 v187, v187, s46, -v210
    s_waitcnt lgkmcnt(6)
    v_mfma_f32_16x16x32_bf16 v[152:155], v[116:119], a[64:67], v[152:155]
    v_fma_f32 v204, -v188, s46, v160
    v_fma_f32 v205, -v189, s46, v160
    v_mfma_f32_16x16x32_bf16 v[156:159], v[116:119], a[68:71], v[156:159]
    s_barrier
    v_fma_f32 v188, v188, s46, -v210
    v_fma_f32 v189, v189, s46, -v210
    s_waitcnt lgkmcnt(5)
    v_mfma_f32_16x16x32_bf16 v[144:147], v[120:123], a[72:75], v[144:147]
    s_waitcnt lgkmcnt(4)
    ds_read_b128 v[96:99], v224 offset:12416
    v_fma_f32 v206, -v190, s46, v160
    v_mfma_f32_16x16x32_bf16 v[148:151], v[120:123], a[76:79], v[148:151]
    ds_read_b128 v[100:103], v224 offset:15488
    v_fma_f32 v207, -v191, s46, v160
    v_fma_f32 v190, v190, s46, -v210
    v_mfma_f32_16x16x32_bf16 v[152:155], v[124:127], a[72:75], v[152:155]
    s_add_u32 m0, s57, 49664
    ds_read_b128 v[104:107], v224 offset:13440
    v_fma_f32 v191, v191, s46, -v210
    v_fma_f32 v208, -v162, s46, v160
    v_mfma_f32_16x16x32_bf16 v[156:159], v[124:127], a[76:79], v[156:159]
    s_waitcnt lgkmcnt(6)
    ds_read_b128 v[108:111], v224 offset:16512
    buffer_load_dwordx4 v34, s[12:15], s43 offen offset:0 sc1 lds
    v_fma_f32 v209, -v163, s46, v160
    v_fma_f32 v162, v162, s46, -v210
    v_mfma_f32_16x16x32_bf16 v[144:147], v[128:131], a[80:83], v[144:147]
    s_waitcnt lgkmcnt(6)
    ds_read_b128 v[112:115], v224 offset:14464
    v_fma_f32 v163, v163, s46, -v210
    v_exp_f32 v192, v192
    v_mfma_f32_16x16x32_bf16 v[148:151], v[128:131], a[84:87], v[148:151]
    s_waitcnt lgkmcnt(6)
    ds_read_b128 v[116:119], v224 offset:17536
    v_exp_f32 v193, v193
    v_exp_f32 v194, v194
    v_mfma_f32_16x16x32_bf16 v[152:155], v[132:135], a[80:83], v[152:155]
    v_exp_f32 v195, v195
    v_exp_f32 v196, v196
    v_mfma_f32_16x16x32_bf16 v[156:159], v[132:135], a[84:87], v[156:159]
    s_add_u32 m0, s57, 49664
    v_exp_f32 v197, v197
    v_add_f32 v212, v192, v194
    v_mfma_f32_16x16x32_bf16 v[144:147], v[136:139], a[88:91], v[144:147]
    s_waitcnt lgkmcnt(6)
    v_add_f32 v213, v193, v195
    v_exp_f32 v198, v198
    v_mfma_f32_16x16x32_bf16 v[148:151], v[136:139], a[92:95], v[148:151]
    s_waitcnt lgkmcnt(5)
    buffer_load_dwordx4 v34, s[12:15], s44 offen offset:1024 sc1 lds
    v_exp_f32 v199, v199
    v_add_f32 v212, v212, v196
    v_mfma_f32_16x16x32_bf16 v[152:155], v[140:143], a[88:91], v[152:155]
    v_add_f32 v213, v213, v197
    v_exp_f32 v200, v200
    v_mfma_f32_16x16x32_bf16 v[156:159], v[140:143], a[92:95], v[156:159]
    s_waitcnt lgkmcnt(4)
    v_exp_f32 v201, v201
    v_add_f32 v212, v212, v198
    v_mfma_f32_16x16x32_bf16 v[144:147], v[96:99], a[96:99], v[144:147]
    ds_read_b128 v[120:123], v224 offset:18560
    v_add_f32 v213, v213, v199
    v_exp_f32 v202, v202
    v_mfma_f32_16x16x32_bf16 v[148:151], v[96:99], a[100:103], v[148:151]
    ds_read_b128 v[124:127], v224 offset:21632
    v_exp_f32 v203, v203
    v_add_f32 v212, v212, v200
    v_mfma_f32_16x16x32_bf16 v[152:155], v[100:103], a[96:99], v[152:155]
    s_waitcnt lgkmcnt(5)
    ds_read_b128 v[128:131], v224 offset:19584
    v_add_f32 v213, v213, v201
    v_exp_f32 v204, v204
    v_mfma_f32_16x16x32_bf16 v[156:159], v[100:103], a[100:103], v[156:159]
    ds_read_b128 v[132:135], v224 offset:22656
    v_exp_f32 v205, v205
    v_add_f32 v212, v212, v202
    v_mfma_f32_16x16x32_bf16 v[144:147], v[104:107], a[104:107], v[144:147]
    s_waitcnt lgkmcnt(6)
    ds_read_b128 v[136:139], v224 offset:20608
    v_add_f32 v213, v213, v203
    v_exp_f32 v206, v206
    v_mfma_f32_16x16x32_bf16 v[148:151], v[104:107], a[108:111], v[148:151]
    s_add_u32 m0, s57, 49664
    ds_read_b128 v[140:143], v224 offset:23680
    v_exp_f32 v207, v207
    v_add_f32 v212, v212, v204
    v_mfma_f32_16x16x32_bf16 v[152:155], v[108:111], a[104:107], v[152:155]
    s_waitcnt lgkmcnt(7)
    buffer_load_dwordx4 v34, s[12:15], s45 offen offset:2048 sc1 lds
    v_add_u32 v34, 82944, v34
    v_add_f32 v213, v213, v205
    v_exp_f32 v208, v208
    v_mfma_f32_16x16x32_bf16 v[156:159], v[108:111], a[108:111], v[156:159]
    v_exp_f32 v209, v209
    v_add_f32 v212, v212, v206
    v_mfma_f32_16x16x32_bf16 v[144:147], v[112:115], a[112:115], v[144:147]
    v_add_f32 v213, v213, v207
    v_exp_f32 v176, v176
    v_mfma_f32_16x16x32_bf16 v[148:151], v[112:115], a[116:119], v[148:151]
    s_waitcnt vmcnt(7)
    v_exp_f32 v177, v177
    v_exp_f32 v178, v178
    s_waitcnt lgkmcnt(6)
    v_mfma_f32_16x16x32_bf16 v[152:155], v[116:119], a[112:115], v[152:155]
    v_exp_f32 v179, v179
    v_exp_f32 v180, v180
    v_mfma_f32_16x16x32_bf16 v[156:159], v[116:119], a[116:119], v[156:159]
    s_barrier
    v_exp_f32 v181, v181
    s_waitcnt lgkmcnt(5)
    v_mfma_f32_16x16x32_bf16 v[144:147], v[120:123], a[120:123], v[144:147]
    s_mov_b32 s62, 393216
    ds_read_b128 v[96:99], v224 offset:24832
    v_add_f32 v214, v176, v178
    v_add_f32 v215, v177, v179
    v_mfma_f32_16x16x32_bf16 v[148:151], v[120:123], a[124:127], v[148:151]
    s_waitcnt lgkmcnt(5)
    buffer_load_dwordx2 v[244:245], v39, s[20:23], s62 offen sc1
    ds_read_b128 v[100:103], v224 offset:27904
    v_exp_f32 v182, v182
    v_exp_f32 v183, v183
    v_mfma_f32_16x16x32_bf16 v[152:155], v[124:127], a[120:123], v[152:155]
    s_add_u32 m0, s57, 0
    ds_read_b128 v[104:107], v224 offset:25856
    v_add_f32 v214, v214, v180
    v_add_f32 v215, v215, v181
    v_mfma_f32_16x16x32_bf16 v[156:159], v[124:127], a[124:127], v[156:159]
    s_waitcnt lgkmcnt(6)
    ds_read_b128 v[108:111], v224 offset:28928
    buffer_load_dwordx4 v34, s[12:15], s37 offen offset:0 sc1 lds
    v_exp_f32 v184, v184
    v_exp_f32 v185, v185
    v_mfma_f32_16x16x32_bf16 v[144:147], v[128:131], a[128:131], v[144:147]
    s_waitcnt lgkmcnt(6)
    ds_read_b128 v[112:115], v224 offset:26880
    v_add_f32 v214, v214, v182
    v_add_f32 v215, v215, v183
    v_mfma_f32_16x16x32_bf16 v[148:151], v[128:131], a[132:135], v[148:151]
    s_waitcnt lgkmcnt(6)
    ds_read_b128 v[116:119], v224 offset:29952
    v_exp_f32 v186, v186
    v_exp_f32 v187, v187
    v_mfma_f32_16x16x32_bf16 v[152:155], v[132:135], a[128:131], v[152:155]
    v_add_f32 v214, v214, v184
    v_add_f32 v215, v215, v185
    v_mfma_f32_16x16x32_bf16 v[156:159], v[132:135], a[132:135], v[156:159]
    s_add_u32 m0, s57, 0
    v_exp_f32 v188, v188
    v_exp_f32 v189, v189
    v_mfma_f32_16x16x32_bf16 v[144:147], v[136:139], a[136:139], v[144:147]
    s_waitcnt lgkmcnt(6)
    v_add_f32 v214, v214, v186
    v_add_f32 v215, v215, v187
    v_mfma_f32_16x16x32_bf16 v[148:151], v[136:139], a[140:143], v[148:151]
    s_waitcnt lgkmcnt(5)
    buffer_load_dwordx4 v34, s[12:15], s38 offen offset:1024 sc1 lds
    v_exp_f32 v190, v190
    v_exp_f32 v191, v191
    v_mfma_f32_16x16x32_bf16 v[152:155], v[140:143], a[136:139], v[152:155]
    v_add_f32 v214, v214, v188
    v_add_f32 v215, v215, v189
    v_mfma_f32_16x16x32_bf16 v[156:159], v[140:143], a[140:143], v[156:159]
    v_exp_f32 v162, v162
    v_exp_f32 v163, v163
    v_mfma_f32_16x16x32_bf16 v[40:43], v[96:99], a[0:3], 0
    s_waitcnt lgkmcnt(4)
    ds_read_b128 v[120:123], v224 offset:30976
    v_add_f32 v214, v214, v190
    v_add_f32 v215, v215, v191
    v_cvt_pk_bf16_f32 v144, v144, v145
    v_mfma_f32_16x16x32_bf16 v[44:47], v[96:99], a[4:7], 0
    ds_read_b128 v[124:127], v224 offset:34048
    v_add_f32 v212, v212, v208
    v_add_f32 v213, v213, v209
    v_cvt_pk_bf16_f32 v145, v146, v147
    v_mfma_f32_16x16x32_bf16 v[48:51], v[100:103], a[0:3], 0
    s_waitcnt lgkmcnt(5)
    ds_read_b128 v[128:131], v224 offset:32000
    v_add_f32 v214, v214, v162
    v_add_f32 v215, v215, v163
    v_mfma_f32_16x16x32_bf16 v[52:55], v[100:103], a[4:7], 0
    ds_write_b64 v35, v[144:145] offset:2560
    ds_read_b128 v[132:135], v224 offset:35072
    v_add_f32 v212, v212, v213
    v_add_f32 v214, v214, v215
    v_cvt_pk_bf16_f32 v148, v148, v149
    v_mfma_f32_16x16x32_bf16 v[40:43], v[104:107], a[8:11], v[40:43]
    s_waitcnt lgkmcnt(7)
    ds_read_b128 v[136:139], v224 offset:33024
    v_rcp_f32 v212, v212
    v_rcp_f32 v214, v214
    v_cvt_pk_bf16_f32 v149, v150, v151
    v_mfma_f32_16x16x32_bf16 v[44:47], v[104:107], a[12:15], v[44:47]
    s_add_u32 m0, s57, 0
    ds_read_b128 v[140:143], v224 offset:36096
    v_mul_f32 v192, v192, v212
    v_mul_f32 v193, v193, v212
    v_mfma_f32_16x16x32_bf16 v[48:51], v[108:111], a[8:11], v[48:51]
    s_waitcnt lgkmcnt(8)
    ds_write_b64 v35, v[148:149] offset:2816
    buffer_load_dwordx4 v34, s[12:15], s39 offen offset:2048 sc1 lds
    v_cvt_pk_bf16_f32 v192, v192, v193
    v_mul_f32 v194, v194, v212
    v_cvt_pk_bf16_f32 v152, v152, v153
    v_mfma_f32_16x16x32_bf16 v[52:55], v[108:111], a[12:15], v[52:55]
    v_mul_f32 v195, v195, v212
    v_cvt_pk_bf16_f32 v193, v194, v195
    v_cvt_pk_bf16_f32 v153, v154, v155
    v_mfma_f32_16x16x32_bf16 v[40:43], v[112:115], a[16:19], v[40:43]
    s_waitcnt lgkmcnt(8)
    v_mul_f32 v196, v196, v212
    v_mul_f32 v197, v197, v212
    v_mfma_f32_16x16x32_bf16 v[44:47], v[112:115], a[20:23], v[44:47]
    ds_write_b64 v35, v[152:153] offset:3840
    v_cvt_pk_bf16_f32 v194, v196, v197
    v_mul_f32 v198, v198, v212
    v_cvt_pk_bf16_f32 v156, v156, v157
    v_mfma_f32_16x16x32_bf16 v[48:51], v[116:119], a[16:19], v[48:51]
    v_mul_f32 v199, v199, v212
    v_cvt_pk_bf16_f32 v195, v198, v199
    v_cvt_pk_bf16_f32 v157, v158, v159
    v_mfma_f32_16x16x32_bf16 v[52:55], v[116:119], a[20:23], v[52:55]
    ds_write_b128 v231, v[192:195] offset:5120
    ds_write_b64 v35, v[156:157] offset:4096
    s_waitcnt vmcnt(7)
    s_barrier
    s_waitcnt lgkmcnt(10)
    v_mfma_f32_16x16x32_bf16 v[40:43], v[120:123], a[24:27], v[40:43]
    ds_read_b128 v[96:99], v224 offset:37248
    v_mul_f32 v200, v200, v212
    v_mul_f32 v201, v201, v212
    s_waitcnt vmcnt(3)
    v_cmp_ne_u64 vcc, s[58:59], v[244:245]
    s_cbranch_vccz .Lqf1
    s_mov_b32 s62, 393216
    s_mov_b32 s63, 300000
.Lpf1:
    buffer_load_dwordx2 v[244:245], v39, s[20:23], s62 offen sc1
    s_waitcnt vmcnt(0)
    v_cmp_ne_u64 vcc, s[58:59], v[244:245]
    s_sub_u32 s63, s63, 1
    s_cbranch_scc1 .Lend
    s_cbranch_vccnz .Lpf1
.Lqf1:
    v_mfma_f32_16x16x32_bf16 v[44:47], v[120:123], a[28:31], v[44:47]
    s_add_u32 m0, s57, 12416
    ds_read_b128 v[100:103], v224 offset:40320
    buffer_load_dwordx4 v34, s[12:15], s40 offen offset:0 sc1 lds
    v_cvt_pk_bf16_f32 v196, v200, v201
    v_mul_f32 v202, v202, v212
    s_waitcnt lgkmcnt(11)
    v_mfma_f32_16x16x32_bf16 v[48:51], v[124:127], a[24:27], v[48:51]
    s_add_u32 m0, s57, 12416
    ds_read_b128 v[104:107], v224 offset:38272
    v_mul_f32 v203, v203, v212
    v_cvt_pk_bf16_f32 v197, v202, v203
    v_mfma_f32_16x16x32_bf16 v[52:55], v[124:127], a[28:31], v[52:55]
    s_waitcnt lgkmcnt(11)
    ds_read_b128 v[108:111], v224 offset:41344
    v_mul_f32 v204, v204, v212
    v_mul_f32 v205, v205, v212
    v_mfma_f32_16x16x32_bf16 v[40:43], v[128:131], a[32:35], v[40:43]
    s_waitcnt lgkmcnt(10)
    buffer_load_dwordx4 v34, s[12:15], s41 offen offset:1024 sc1 lds
    ds_read_b128 v[112:115], v224 offset:39296
    v_cvt_pk_bf16_f32 v198, v204, v205
    v_mul_f32 v206, v206, v212
    v_mfma_f32_16x16x32_bf16 v[44:47], v[128:131], a[36:39], v[44:47]
    s_cmp_ge_u32 s99, 8
    ds_read_b128 v[116:119], v224 offset:42368
    v_mul_f32 v207, v207, v212
    v_cvt_pk_bf16_f32 v199, v206, v207
    v_mfma_f32_16x16x32_bf16 v[48:51], v[132:135], a[32:35], v[48:51]
    s_cselect_b32 s26, 15360, 0
    s_add_u32 m0, s55, 0
    s_movk_i32 s19, 0
    ds_write_b128 v232, v[196:199] offset:5120
    buffer_load_dwordx4 v224, s[24:27], s19 offen offset:0 sc1 lds
    v_mul_f32 v208, v208, v212
    v_mfma_f32_16x16x32_bf16 v[52:55], v[132:135], a[36:39], v[52:55]
    s_add_u32 m0, s55, 0
    v_mul_f32 v209, v209, v212
    v_cvt_pk_bf16_f32 v200, v208, v209
    s_waitcnt lgkmcnt(12)
    v_mfma_f32_16x16x32_bf16 v[40:43], v[136:139], a[40:43], v[40:43]
    s_waitcnt lgkmcnt(11)
    ds_write_b32 v233, v200 offset:5120
    v_mul_f32 v176, v176, v214
    v_mfma_f32_16x16x32_bf16 v[44:47], v[136:139], a[44:47], v[44:47]
    v_mul_f32 v177, v177, v214
    v_cvt_pk_bf16_f32 v176, v176, v177
    v_mfma_f32_16x16x32_bf16 v[48:51], v[140:143], a[40:43], v[48:51]
    s_waitcnt lgkmcnt(7)
    buffer_load_dwordx4 v224, s[24:27], s19 offen offset:1024 sc1 lds
    s_add_u32 m0, s55, 2048
    s_movk_i32 s19, 2048
    v_mul_f32 v178, v178, v214
    v_mul_f32 v179, v179, v214
    v_mfma_f32_16x16x32_bf16 v[52:55], v[140:143], a[44:47], v[52:55]
    v_cvt_pk_bf16_f32 v177, v178, v179
    v_mul_f32 v180, v180, v214
    v_mfma_f32_16x16x32_bf16 v[40:43], v[96:99], a[48:51], v[40:43]
    s_waitcnt lgkmcnt(6)
    ds_read_b128 v[120:123], v224 offset:43392
    v_mul_f32 v181, v181, v214
    v_cvt_pk_bf16_f32 v178, v180, v181
    v_mfma_f32_16x16x32_bf16 v[44:47], v[96:99], a[52:55], v[44:47]
    buffer_load_dwordx4 v224, s[24:27], s19 offen offset:0 sc1 lds
    ds_read_b128 v[124:127], v224 offset:46464
    v_mul_f32 v182, v182, v214
    v_mul_f32 v183, v183, v214
    v_mfma_f32_16x16x32_bf16 v[48:51], v[100:103], a[48:51], v[48:51]
    s_add_u32 m0, s57, 12416
    ds_read_b128 v[128:131], v224 offset:44416
    v_cvt_pk_bf16_f32 v179, v182, v183
    v_mfma_f32_16x16x32_bf16 v[52:55], v[100:103], a[52:55], v[52:55]
    s_waitcnt lgkmcnt(8)
    ds_write_b128 v231, v[176:179] offset:0
    buffer_load_dwordx4 v34, s[12:15], s42 offen offset:2048 sc1 lds
    ds_read_b128 v[132:135], v224 offset:47488
    v_mul_f32 v184, v184, v214
    v_mul_f32 v185, v185, v214
    v_mfma_f32_16x16x32_bf16 v[40:43], v[104:107], a[56:59], v[40:43]
    s_waitcnt lgkmcnt(9)
    ds_read_b128 v[136:139], v224 offset:45440
    v_cvt_pk_bf16_f32 v180, v184, v185
    v_mul_f32 v186, v186, v214
    v_mfma_f32_16x16x32_bf16 v[44:47], v[104:107], a[60:63], v[44:47]
    s_add_u32 m0, s55, 2048
    ds_read_b128 v[140:143], v224 offset:48512
    v_mul_f32 v187, v187, v214
    v_cvt_pk_bf16_f32 v181, v186, v187
    v_mfma_f32_16x16x32_bf16 v[48:51], v[108:111], a[56:59], v[48:51]
    s_waitcnt lgkmcnt(10)
    buffer_load_dwordx4 v224, s[24:27], s19 offen offset:1024 sc1 lds
    v_mul_f32 v188, v188, v214
    v_mul_f32 v189, v189, v214
    v_mfma_f32_16x16x32_bf16 v[52:55], v[108:111], a[60:63], v[52:55]
    s_waitcnt lgkmcnt(9)
    v_cvt_pk_bf16_f32 v182, v188, v189
    v_mul_f32 v190, v190, v214
    v_mfma_f32_16x16x32_bf16 v[40:43], v[112:115], a[64:67], v[40:43]
    s_add_u32 m0, s55, 2048
    v_mul_f32 v191, v191, v214
    v_cvt_pk_bf16_f32 v183, v190, v191
    v_mfma_f32_16x16x32_bf16 v[44:47], v[112:115], a[68:71], v[44:47]
    ds_write_b128 v232, v[180:183] offset:0
    v_mul_f32 v162, v162, v214
    v_mfma_f32_16x16x32_bf16 v[48:51], v[116:119], a[64:67], v[48:51]
    buffer_load_dwordx4 v224, s[24:27], s19 offen offset:2048 sc1 lds
    v_mul_f32 v163, v163, v214
    v_cvt_pk_bf16_f32 v184, v162, v163
    v_mfma_f32_16x16x32_bf16 v[52:55], v[116:119], a[68:71], v[52:55]
    ds_write_b32 v233, v184 offset:0
    s_waitcnt lgkmcnt(0)
    s_barrier
    v_mfma_f32_16x16x32_bf16 v[40:43], v[120:123], a[72:75], v[40:43]
    s_add_u32 m0, s57, 24832
    ds_read_b128 v[96:99], v224 offset:49664
    ds_read_b64_tr_b16 a[144:145], v88 offset:0
    ds_read_b64_tr_b16 a[148:149], v92 offset:0
    v_mfma_f32_16x16x32_bf16 v[44:47], v[120:123], a[76:79], v[44:47]
    ds_read_b128 v[100:103], v224 offset:52736
    buffer_load_dwordx4 v34, s[12:15], s43 offen offset:0 sc1 lds
    ds_read_b64_tr_b16 a[146:147], v89 offset:0
    v_mfma_f32_16x16x32_bf16 v[48:51], v[124:127], a[72:75], v[48:51]
    ds_read_b128 v[104:107], v224 offset:50688
    ds_read_b64_tr_b16 a[150:151], v93 offset:0
    v_mfma_f32_16x16x32_bf16 v[52:55], v[124:127], a[76:79], v[52:55]
    s_add_u32 m0, s57, 24832
    ds_read_b128 v[108:111], v224 offset:53760
    ds_read_b64_tr_b16 a[152:153], v90 offset:0
    ds_read_b64_tr_b16 a[156:157], v94 offset:0
    v_mfma_f32_16x16x32_bf16 v[40:43], v[128:131], a[80:83], v[40:43]
    ds_read_b128 v[112:115], v224 offset:51712
    buffer_load_dwordx4 v34, s[12:15], s44 offen offset:1024 sc1 lds
    ds_read_b64_tr_b16 a[154:155], v91 offset:0
    v_mfma_f32_16x16x32_bf16 v[44:47], v[128:131], a[84:87], v[44:47]
    s_cmp_ge_u32 s99, 6
    ds_read_b128 v[116:119], v224 offset:54784
    ds_read_b64_tr_b16 a[158:159], v95 offset:0
    v_mfma_f32_16x16x32_bf16 v[48:51], v[132:135], a[80:83], v[48:51]
    s_cselect_b32 s26, 15360, 0
    ds_read_b64_tr_b16 a[160:161], v88 offset:7680
    ds_read_b64_tr_b16 a[164:165], v92 offset:7680
    v_mfma_f32_16x16x32_bf16 v[52:55], v[132:135], a[84:87], v[52:55]
    s_add_u32 m0, s55, 5120
    s_movk_i32 s19, 5120
    ds_read_b64_tr_b16 a[162:163], v89 offset:7680
    buffer_load_dwordx4 v224, s[24:27], s19 offen offset:0 sc1 lds
    v_mfma_f32_16x16x32_bf16 v[40:43], v[136:139], a[88:91], v[40:43]
    s_add_u32 m0, s55, 5120
    ds_read_b64_tr_b16 a[166:167], v93 offset:7680
    ds_read_b64_tr_b16 a[168:169], v90 offset:7680
    v_mfma_f32_16x16x32_bf16 v[44:47], v[136:139], a[92:95], v[44:47]
    s_waitcnt lgkmcnt(15)
    ds_read_b64_tr_b16 a[172:173], v94 offset:7680
    ds_read_b64_tr_b16 a[170:171], v91 offset:7680
    v_mfma_f32_16x16x32_bf16 v[48:51], v[140:143], a[88:91], v[48:51]
    s_waitcnt lgkmcnt(14)
    ds_read_b64_tr_b16 a[174:175], v95 offset:7680
    ds_read_b128 v[120:123], v224 offset:55808
    v_mfma_f32_16x16x32_bf16 v[52:55], v[140:143], a[92:95], v[52:55]
    buffer_load_dwordx4 v224, s[24:27], s19 offen offset:1024 sc1 lds
    ds_read_b64_tr_b16 a[176:177], v88 offset:15360
    v_mfma_f32_16x16x32_bf16 v[40:43], v[96:99], a[96:99], v[40:43]
    s_add_u32 m0, s57, 24832
    ds_read_b64_tr_b16 a[180:181], v92 offset:15360
    ds_read_b128 v[124:127], v224 offset:58880
    v_mfma_f32_32x32x16_bf16 v[176:191], a[144:147], a[148:151], 0
    ds_read_b64_tr_b16 a[178:179], v89 offset:15360
    ds_read_b128 v[128:131], v224 offset:56832
    ds_read_b64_tr_b16 a[182:183], v93 offset:15360
    ds_read_b128 v[132:135], v224 offset:59904
    ds_read_b64_tr_b16 a[184:185], v90 offset:15360
    v_mfma_f32_16x16x32_bf16 v[44:47], v[96:99], a[100:103], v[44:47]
    s_waitcnt lgkmcnt(15)
    buffer_load_dwordx4 v34, s[12:15], s45 offen offset:2048 sc1 lds
    v_mfma_f32_16x16x32_bf16 v[48:51], v[100:103], a[96:99], v[48:51]
    ds_read_b64_tr_b16 a[188:189], v94 offset:15360
    ds_read_b128 v[136:139], v224 offset:57856
    v_mfma_f32_16x16x32_bf16 v[52:55], v[100:103], a[100:103], v[52:55]
    s_add_u32 m0, s55, 7168
    ds_read_b64_tr_b16 a[186:187], v91 offset:15360
    ds_read_b128 v[140:143], v224 offset:60928
    v_mfma_f32_32x32x16_bf16 v[176:191], a[152:155], a[156:159], v[176:191]
    s_movk_i32 s19, 7168
    ds_read_b64_tr_b16 a[190:191], v95 offset:15360
    ds_read_b64_tr_b16 a[192:193], v88 offset:23040
    buffer_load_dwordx4 v224, s[24:27], s19 offen offset:0 sc1 lds
    ds_read_b64_tr_b16 a[196:197], v92 offset:23040
    ds_read_b64_tr_b16 a[194:195], v89 offset:23040
    v_mfma_f32_16x16x32_bf16 v[40:43], v[104:107], a[104:107], v[40:43]
    s_add_u32 m0, s55, 7168
    ds_read_b64_tr_b16 a[198:199], v93 offset:23040
    v_mfma_f32_16x16x32_bf16 v[44:47], v[104:107], a[108:111], v[44:47]
    s_waitcnt lgkmcnt(15)
    ds_read_b64_tr_b16 a[200:201], v90 offset:23040
    v_mfma_f32_16x16x32_bf16 v[48:51], v[108:111], a[104:107], v[48:51]
    ds_read_b64_tr_b16 a[204:205], v94 offset:23040
    v_mfma_f32_32x32x16_bf16 v[176:191], a[160:163], a[164:167], v[176:191]
    buffer_load_dwordx4 v224, s[24:27], s19 offen offset:1024 sc1 lds
    ds_read_b64_tr_b16 a[202:203], v91 offset:23040
    ds_read_b64_tr_b16 a[206:207], v95 offset:23040
    s_waitcnt vmcnt(15)
    s_waitcnt lgkmcnt(0)
    v_mfma_f32_16x16x32_bf16 v[52:55], v[108:111], a[108:111], v[52:55]
    s_barrier
    v_mfma_f32_16x16x32_bf16 v[40:43], v[112:115], a[112:115], v[40:43]
    ds_read_b128 v[96:99], v224 offset:0
    v_mfma_f32_16x16x32_bf16 v[44:47], v[112:115], a[116:119], v[44:47]
    s_add_u32 m0, s55, 7168
    ds_read_b128 v[100:103], v224 offset:3072
    v_mfma_f32_32x32x16_bf16 v[176:191], a[168:171], a[172:175], v[176:191]
    ds_read_b128 v[104:107], v224 offset:1024
    ds_read_b128 v[108:111], v224 offset:4096
    buffer_load_dwordx4 v224, s[24:27], s19 offen offset:2048 sc1 lds
    v_mfma_f32_16x16x32_bf16 v[48:51], v[116:119], a[112:115], v[48:51]
    v_mfma_f32_16x16x32_bf16 v[52:55], v[116:119], a[116:119], v[52:55]
    ds_read_b128 v[112:115], v224 offset:2048
    v_mfma_f32_16x16x32_bf16 v[40:43], v[120:123], a[120:123], v[40:43]
    v_mfma_f32_32x32x16_bf16 v[176:191], a[176:179], a[180:183], v[176:191]
    ds_read_b128 v[116:119], v224 offset:5120
    s_cmp_ge_u32 s99, 4
    s_cselect_b32 s26, 15360, 0
    v_mfma_f32_16x16x32_bf16 v[44:47], v[120:123], a[124:127], v[44:47]
    s_add_u32 m0, s55, 10240
    v_mfma_f32_32x32x16_bf16 v[176:191], a[184:187], a[188:191], v[176:191]
    s_movk_i32 s19, 10240
    buffer_load_dwordx4 v224, s[24:27], s19 offen offset:0 sc1 lds
    v_mfma_f32_16x16x32_bf16 v[48:51], v[124:127], a[120:123], v[48:51]
    v_mfma_f32_32x32x16_bf16 v[176:191], a[192:195], a[196:199], v[176:191]
    v_mfma_f32_16x16x32_bf16 v[52:55], v[124:127], a[124:127], v[52:55]
    v_mfma_f32_32x32x16_bf16 v[176:191], a[200:203], a[204:207], v[176:191]
    v_mfma_f32_16x16x32_bf16 v[40:43], v[128:131], a[128:131], v[40:43]
    v_mfma_f32_16x16x32_bf16 v[44:47], v[128:131], a[132:135], v[44:47]
    v_mfma_f32_16x16x32_bf16 v[48:51], v[132:135], a[128:131], v[48:51]
    v_mfma_f32_16x16x32_bf16 v[52:55], v[132:135], a[132:135], v[52:55]
    v_mfma_f32_16x16x32_bf16 v[40:43], v[136:139], a[136:139], v[40:43]
    v_mfma_f32_16x16x32_bf16 v[44:47], v[136:139], a[140:143], v[44:47]
    s_add_u32 m0, s55, 10240
    v_mfma_f32_16x16x32_bf16 v[48:51], v[140:143], a[136:139], v[48:51]
    s_nop 3
    v_cvt_pk_bf16_f32 v176, v176, v177
    v_cvt_pk_bf16_f32 v177, v178, v179
    v_cvt_pk_bf16_f32 v178, v180, v181
    v_cvt_pk_bf16_f32 v179, v182, v183
    v_cvt_pk_bf16_f32 v180, v184, v185
    s_mov_b32 exec_lo, 0xfffff
    s_mov_b32 exec_hi, 0xfffff
    buffer_store_dwordx4 v[176:179], v11, s[20:23], s5 offen sc1
    s_mov_b32 exec_lo, -1
    s_mov_b32 exec_hi, 0
    buffer_store_dword v180, v10, s[20:23], s5 offen offset:640 sc1
    s_mov_b64 exec, -1
    v_mfma_f32_16x16x32_bf16 v[52:55], v[140:143], a[140:143], v[52:55]
    s_waitcnt lgkmcnt(4)
    ds_read_b128 v[120:123], v224 offset:6144
    v_cvt_pk_bf16_f32 v40, v40, v41
    v_mfma_f32_16x16x32_bf16 v[144:147], v[96:99], a[0:3], 0
    v_cvt_pk_bf16_f32 v41, v42, v43
    v_cvt_pk_bf16_f32 v44, v44, v45
    v_mfma_f32_16x16x32_bf16 v[148:151], v[96:99], a[4:7], 0
    ds_read_b128 v[124:127], v224 offset:9216
    ds_write_b64 v35, v[40:41] offset:0
    v_mfma_f32_16x16x32_bf16 v[152:155], v[100:103], a[0:3], 0
    s_waitcnt lgkmcnt(6)
    ds_read_b128 v[128:131], v224 offset:7168
    v_cvt_pk_bf16_f32 v45, v46, v47
    v_mfma_f32_16x16x32_bf16 v[156:159], v[100:103], a[4:7], 0
    ds_write_b64 v35, v[44:45] offset:256
    ds_read_b128 v[132:135], v224 offset:10240
    buffer_load_dwordx4 v224, s[24:27], s19 offen offset:1024 sc1 lds
    v_cvt_pk_bf16_f32 v48, v48, v49
    v_cvt_pk_bf16_f32 v49, v50, v51
    v_mfma_f32_16x16x32_bf16 v[144:147], v[104:107], a[8:11], v[144:147]
    s_waitcnt lgkmcnt(8)
    ds_read_b128 v[136:139], v224 offset:8192
    ds_write_b64 v35, v[48:49] offset:1280
    v_cvt_pk_bf16_f32 v52, v52, v53
    v_mfma_f32_16x16x32_bf16 v[148:151], v[104:107], a[12:15], v[148:151]
    s_waitcnt lgkmcnt(9)
    ds_read_b128 v[140:143], v224 offset:11264
    v_cvt_pk_bf16_f32 v53, v54, v55
    v_mfma_f32_16x16x32_bf16 v[152:155], v[108:111], a[8:11], v[152:155]
    ds_write_b64 v35, v[52:53] offset:1536
    ds_read_b128 v[192:195], v231
    ds_read_b128 v[196:199], v232
    v_mfma_f32_16x16x32_bf16 v[156:159], v[108:111], a[12:15], v[156:159]
    s_add_u32 m0, s55, 12288
    ds_read_b64 v[200:201], v236
    v_mov_b32 v202, 0
    v_mfma_f32_16x16x32_bf16 v[144:147], v[112:115], a[16:19], v[144:147]
    s_movk_i32 s19, 12288
    v_mov_b32 v203, 0
    v_mfma_f32_16x16x32_bf16 v[148:151], v[112:115], a[20:23], v[148:151]
    buffer_load_dwordx4 v224, s[24:27], s19 offen offset:0 sc1 lds
    s_waitcnt vmcnt(15)
    s_waitcnt lgkmcnt(13)
    v_mfma_f32_16x16x32_bf16 v[152:155], v[116:119], a[16:19], v[152:155]
    s_barrier
    ds_read_b128 v[96:99], v224 offset:12416
    v_mfma_f32_16x16x32_bf16 v[156:159], v[116:119], a[20:23], v[156:159]
    s_mov_b32 s62, 393216
    ds_read_b128 v[100:103], v224 offset:15488
    s_waitcnt lgkmcnt(14)
    v_mfma_f32_16x16x32_bf16 v[144:147], v[120:123], a[24:27], v[144:147]
    s_add_u32 m0, s55, 12288
    ds_read_b128 v[104:107], v224 offset:13440
    buffer_load_dwordx2 v[244:245], v223, s[20:23], s62 offen sc1
    v_mfma_f32_16x16x32_bf16 v[148:151], v[120:123], a[28:31], v[148:151]
    s_waitcnt lgkmcnt(4)
    v_mfma_f32_32x32x16_bf16 v[176:191], v[64:67], v[192:195], 0
    ds_read_b128 v[108:111], v224 offset:16512
    buffer_load_dwordx4 v224, s[24:27], s19 offen offset:1024 sc1 lds
    v_mfma_f32_32x32x16_bf16 v[160:175], v[76:79], v[192:195], 0
    s_waitcnt lgkmcnt(4)
    ds_read_b128 v[112:115], v224 offset:14464
    ds_read_b128 v[116:119], v224 offset:17536
    v_mfma_f32_32x32x16_bf16 v[176:191], v[68:71], v[196:199], v[176:191]
    v_mfma_f32_32x32x16_bf16 v[160:175], v[80:83], v[196:199], v[160:175]
    v_mfma_f32_32x32x16_bf16 v[176:191], v[72:75], v[200:203], v[176:191]
    v_mfma_f32_32x32x16_bf16 v[160:175], v[84:87], v[200:203], v[160:175]
    v_mfma_f32_16x16x32_bf16 v[152:155], v[124:127], a[24:27], v[152:155]
    v_mfma_f32_16x16x32_bf16 v[156:159], v[124:127], a[28:31], v[156:159]
    s_add_u32 m0, s55, 12288
    v_mfma_f32_16x16x32_bf16 v[144:147], v[128:131], a[32:35], v[144:147]
    v_mfma_f32_16x16x32_bf16 v[148:151], v[128:131], a[36:39], v[148:151]
    s_nop 5
    v_max3_f32 v210, v176, v177, v178
    v_mfma_f32_16x16x32_bf16 v[152:155], v[132:135], a[32:35], v[152:155]
    v_min3_f32 v211, v176, v177, v178
    v_max3_f32 v210, v210, v179, v180
    v_min3_f32 v211, v211, v179, v180
    v_max3_f32 v210, v210, v181, v182
    v_min3_f32 v211, v211, v181, v182
    v_max3_f32 v210, v210, v183, v184
    v_min3_f32 v211, v211, v183, v184
    v_max3_f32 v210, v210, v185, v186
    v_min3_f32 v211, v211, v185, v186
    v_max3_f32 v210, v210, v187, v188
    v_min3_f32 v211, v211, v187, v188
    v_max3_f32 v210, v210, v189, v190
    v_min3_f32 v211, v211, v189, v190
    v_max3_f32 v210, v210, v191, v162
    v_min3_f32 v211, v211, v191, v162
    v_max_f32 v210, v210, v163
    v_min_f32 v211, v211, v163
    v_mul_f32 v160, s46, v211
    v_mfma_f32_16x16x32_bf16 v[156:159], v[132:135], a[36:39], v[156:159]
    v_mul_f32 v210, s46, v210
    v_fma_f32 v192, -v176, s46, v160
    v_fma_f32 v193, -v177, s46, v160
    v_mfma_f32_16x16x32_bf16 v[144:147], v[136:139], a[40:43], v[144:147]
    v_fma_f32 v176, v176, s46, -v210
    v_fma_f32 v177, v177, s46, -v210
    v_mfma_f32_16x16x32_bf16 v[148:151], v[136:139], a[44:47], v[148:151]
    buffer_load_dwordx4 v224, s[24:27], s19 offen offset:2048 sc1 lds
    v_fma_f32 v194, -v178, s46, v160
    v_fma_f32 v195, -v179, s46, v160
    v_fma_f32 v178, v178, s46, -v210
    v_mfma_f32_16x16x32_bf16 v[152:155], v[140:143], a[40:43], v[152:155]
    s_waitcnt lgkmcnt(5)
    v_fma_f32 v179, v179, s46, -v210
    v_fma_f32 v196, -v180, s46, v160
    v_fma_f32 v197, -v181, s46, v160
    v_mfma_f32_16x16x32_bf16 v[156:159], v[140:143], a[44:47], v[156:159]
    v_fma_f32 v180, v180, s46, -v210
    v_fma_f32 v181, v181, s46, -v210
    v_mfma_f32_16x16x32_bf16 v[144:147], v[96:99], a[48:51], v[144:147]
    s_waitcnt lgkmcnt(4)
    ds_read_b128 v[120:123], v224 offset:18560
    v_fma_f32 v198, -v182, s46, v160
    v_fma_f32 v199, -v183, s46, v160
    v_fma_f32 v182, v182, s46, -v210
    v_mfma_f32_16x16x32_bf16 v[148:151], v[96:99], a[52:55], v[148:151]
    ds_read_b128 v[124:127], v224 offset:21632
    v_fma_f32 v183, v183, s46, -v210
    v_fma_f32 v200, -v184, s46, v160
    v_fma_f32 v201, -v185, s46, v160
    v_mfma_f32_16x16x32_bf16 v[152:155], v[100:103], a[48:51], v[152:155]
    s_waitcnt lgkmcnt(5)
    ds_read_b128 v[128:131], v224 offset:19584
    v_fma_f32 v184, v184, s46, -v210
    v_fma_f32 v185, v185, s46, -v210
    v_mfma_f32_16x16x32_bf16 v[156:159], v[100:103], a[52:55], v[156:159]
    ds_read_b128 v[132:135], v224 offset:22656
    v_fma_f32 v202, -v186, s46, v160
    v_fma_f32 v203, -v187, s46, v160
    v_fma_f32 v186, v186, s46, -v210
    v_mfma_f32_16x16x32_bf16 v[144:147], v[104:107], a[56:59], v[144:147]
    s_waitcnt lgkmcnt(6)
    ds_read_b128 v[136:139], v224 offset:20608
    v_fma_f32 v187, v187, s46, -v210
    v_fma_f32 v204, -v188, s46, v160
    v_fma_f32 v205, -v189, s46, v160
    v_mfma_f32_16x16x32_bf16 v[148:151], v[104:107], a[60:63], v[148:151]
    ds_read_b128 v[140:143], v224 offset:23680
    v_fma_f32 v188, v188, s46, -v210
    v_fma_f32 v189, v189, s46, -v210
    v_mfma_f32_16x16x32_bf16 v[152:155], v[108:111], a[56:59], v[152:155]
    s_waitcnt lgkmcnt(7)
    v_fma_f32 v206, -v190, s46, v160
    v_fma_f32 v207, -v191, s46, v160
    v_fma_f32 v190, v190, s46, -v210
    v_mfma_f32_16x16x32_bf16 v[156:159], v[108:111], a[60:63], v[156:159]
    s_waitcnt lgkmcnt(6)
    v_fma_f32 v191, v191, s46, -v210
    v_fma_f32 v208, -v162, s46, v160
    v_fma_f32 v209, -v163, s46, v160
    v_mfma_f32_16x16x32_bf16 v[144:147], v[112:115], a[64:67], v[144:147]
    v_fma_f32 v162, v162, s46, -v210
    v_fma_f32 v163, v163, s46, -v210
    v_mfma_f32_16x16x32_bf16 v[148:151], v[112:115], a[68:71], v[148:151]
    v_exp_f32 v192, v192
    v_exp_f32 v193, v193
    v_exp_f32 v194, v194
    v_mfma_f32_16x16x32_bf16 v[152:155], v[116:119], a[64:67], v[152:155]
    s_waitcnt vmcnt(11)
    v_exp_f32 v195, v195
    v_exp_f32 v196, v196
    v_exp_f32 v197, v197
    v_mfma_f32_16x16x32_bf16 v[156:159], v[116:119], a[68:71], v[156:159]
    v_add_f32 v212, v192, v194
    v_add_f32 v213, v193, v195
    s_barrier
    s_waitcnt lgkmcnt(5)
    v_mfma_f32_16x16x32_bf16 v[144:147], v[120:123], a[72:75], v[144:147]
    s_waitcnt lgkmcnt(4)
    ds_read_b128 v[96:99], v224 offset:24832
    v_exp_f32 v198, v198
    v_exp_f32 v199, v199
    v_add_f32 v212, v212, v196
    v_mfma_f32_16x16x32_bf16 v[148:151], v[120:123], a[76:79], v[148:151]
    ds_read_b128 v[100:103], v224 offset:27904
    v_add_f32 v213, v213, v197
    v_exp_f32 v200, v200
    v_exp_f32 v201, v201
    v_mfma_f32_16x16x32_bf16 v[152:155], v[124:127], a[72:75], v[152:155]
    s_waitcnt lgkmcnt(5)
    ds_read_b128 v[104:107], v224 offset:25856
    v_add_f32 v212, v212, v198
    v_add_f32 v213, v213, v199
    v_mfma_f32_16x16x32_bf16 v[156:159], v[124:127], a[76:79], v[156:159]
    ds_read_b128 v[108:111], v224 offset:28928
    v_exp_f32 v202, v202
    v_exp_f32 v203, v203
    v_add_f32 v212, v212, v200
    v_mfma_f32_16x16x32_bf16 v[144:147], v[128:131], a[80:83], v[144:147]
    s_waitcnt lgkmcnt(6)
    ds_read_b128 v[112:115], v224 offset:26880
    v_add_f32 v213, v213, v201
    v_exp_f32 v204, v204
    v_mfma_f32_16x16x32_bf16 v[148:151], v[128:131], a[84:87], v[148:151]
    ds_read_b128 v[116:119], v224 offset:29952
    v_exp_f32 v205, v205
    v_add_f32 v212, v212, v202
    v_add_f32 v213, v213, v203
    v_mfma_f32_16x16x32_bf16 v[152:155], v[132:135], a[80:83], v[152:155]
    s_waitcnt lgkmcnt(7)
    v_exp_f32 v206, v206
    v_exp_f32 v207, v207
    v_add_f32 v212, v212, v204
    v_mfma_f32_16x16x32_bf16 v[156:159], v[132:135], a[84:87], v[156:159]
    s_waitcnt lgkmcnt(6)
    v_add_f32 v213, v213, v205
    v_exp_f32 v208, v208
    v_mfma_f32_16x16x32_bf16 v[144:147], v[136:139], a[88:91], v[144:147]
    v_exp_f32 v209, v209
    v_add_f32 v212, v212, v206
    v_add_f32 v213, v213, v207
    v_mfma_f32_16x16x32_bf16 v[148:151], v[136:139], a[92:95], v[148:151]
    s_waitcnt lgkmcnt(5)
    v_exp_f32 v176, v176
    v_exp_f32 v177, v177
    v_mfma_f32_16x16x32_bf16 v[152:155], v[140:143], a[88:91], v[152:155]
    v_exp_f32 v178, v178
    v_exp_f32 v179, v179
    v_exp_f32 v180, v180
    v_mfma_f32_16x16x32_bf16 v[156:159], v[140:143], a[92:95], v[156:159]
    v_exp_f32 v181, v181
    v_add_f32 v214, v176, v178
    v_mfma_f32_16x16x32_bf16 v[144:147], v[96:99], a[96:99], v[144:147]
    s_waitcnt lgkmcnt(4)
    ds_read_b128 v[120:123], v224 offset:30976
    v_add_f32 v215, v177, v179
    v_exp_f32 v182, v182
    v_exp_f32 v183, v183
    v_mfma_f32_16x16x32_bf16 v[148:151], v[96:99], a[100:103], v[148:151]
    ds_read_b128 v[124:127], v224 offset:34048
    v_add_f32 v214, v214, v180
    v_add_f32 v215, v215, v181
    v_exp_f32 v184, v184
    v_mfma_f32_16x16x32_bf16 v[152:155], v[100:103], a[96:99], v[152:155]
    s_waitcnt lgkmcnt(5)
    ds_read_b128 v[128:131], v224 offset:32000
    v_exp_f32 v185, v185
    v_add_f32 v214, v214, v182
    v_mfma_f32_16x16x32_bf16 v[156:159], v[100:103], a[100:103], v[156:159]
    ds_read_b128 v[132:135], v224 offset:35072
    v_add_f32 v215, v215, v183
    v_exp_f32 v186, v186
    v_exp_f32 v187, v187
    v_mfma_f32_16x16x32_bf16 v[144:147], v[104:107], a[104:107], v[144:147]
    s_waitcnt lgkmcnt(6)
    ds_read_b128 v[136:139], v224 offset:33024
    v_add_f32 v214, v214, v184
    v_add_f32 v215, v215, v185
    v_exp_f32 v188, v188
    v_mfma_f32_16x16x32_bf16 v[148:151], v[104:107], a[108:111], v[148:151]
    ds_read_b128 v[140:143], v224 offset:36096
    v_exp_f32 v189, v189
    v_add_f32 v214, v214, v186
    v_mfma_f32_16x16x32_bf16 v[152:155], v[108:111], a[104:107], v[152:155]
    s_waitcnt lgkmcnt(7)
    v_add_f32 v215, v215, v187
    v_exp_f32 v190, v190
    v_exp_f32 v191, v191
    v_mfma_f32_16x16x32_bf16 v[156:159], v[108:111], a[108:111], v[156:159]
    s_waitcnt lgkmcnt(6)
    v_add_f32 v214, v214, v188
    v_add_f32 v215, v215, v189
    v_exp_f32 v162, v162
    v_mfma_f32_16x16x32_bf16 v[144:147], v[112:115], a[112:115], v[144:147]
    v_exp_f32 v163, v163
    v_add_f32 v214, v214, v190
    v_mfma_f32_16x16x32_bf16 v[148:151], v[112:115], a[116:119], v[148:151]
    v_add_f32 v215, v215, v191
    v_add_f32 v212, v212, v208
    v_add_f32 v213, v213, v209
    v_mfma_f32_16x16x32_bf16 v[152:155], v[116:119], a[112:115], v[152:155]
    s_waitcnt vmcnt(2)
    v_add_f32 v214, v214, v162
    v_add_f32 v215, v215, v163
    v_add_f32 v212, v212, v213
    v_mfma_f32_16x16x32_bf16 v[156:159], v[116:119], a[116:119], v[156:159]
    v_add_f32 v214, v214, v215
    v_rcp_f32 v212, v212
    v_cmp_ne_u64 vcc, s[58:59], v[244:245]
    s_cbranch_vccz .Lqfo
    s_mov_b32 s62, 393216
    s_mov_b32 s63, 300000
.Lpfo:
    buffer_load_dwordx2 v[244:245], v223, s[20:23], s62 offen sc1
    s_waitcnt vmcnt(0)
    v_cmp_ne_u64 vcc, s[58:59], v[244:245]
    s_sub_u32 s63, s63, 1
    s_cbranch_scc1 .Lend
    s_cbranch_vccnz .Lpfo
.Lqfo:
    s_waitcnt vmcnt(0)
    s_cmp_ge_u32 s28, 2
    s_cbranch_scc1 .Lmk2
    s_add_u32 s63, s99, 6
    s_min_u32 s63, s63, 8
    s_cmp_ge_u32 s99, 8
    s_cbranch_scc1 .Lmk2
    v_and_b32 v60, 31, v0
    v_bfe_u32 v61, v0, 5, 1
    v_mul_u32_u24 v61, 1280, v61
    v_lshl_add_u32 v60, v60, 3, v61
    v_add_u32 v60, s55, v60
    v_mov_b32 v61, 0xf149
.Lmk:
    ds_write_b16 v60, v61 offset:1028
    v_add_u32 v60, 2560, v60
    s_add_u32 s99, s99, 1
    s_cmp_lt_u32 s99, s63
    s_cbranch_scc1 .Lmk
    s_waitcnt lgkmcnt(0)
.Lmk2:
    s_barrier
    s_waitcnt lgkmcnt(5)
    v_mfma_f32_16x16x32_bf16 v[144:147], v[120:123], a[120:123], v[144:147]
    s_mov_b32 s62, 262144
    buffer_store_dwordx2 v[246:247], v1, s[20:23], s62 offen sc1
    v_rcp_f32 v214, v214
    v_mul_f32 v192, v192, v212
    v_mfma_f32_16x16x32_bf16 v[148:151], v[120:123], a[124:127], v[148:151]
    s_waitcnt lgkmcnt(3)
    v_mul_f32 v193, v193, v212
    v_cvt_pk_bf16_f32 v192, v192, v193
    v_mul_f32 v194, v194, v212
    v_mfma_f32_16x16x32_bf16 v[152:155], v[124:127], a[120:123], v[152:155]
    v_mul_f32 v195, v195, v212
    v_cvt_pk_bf16_f32 v193, v194, v195
    v_mfma_f32_16x16x32_bf16 v[156:159], v[124:127], a[124:127], v[156:159]
    s_waitcnt lgkmcnt(2)
    v_mul_f32 v196, v196, v212
    v_mul_f32 v197, v197, v212
    v_cvt_pk_bf16_f32 v194, v196, v197
    v_mfma_f32_16x16x32_bf16 v[144:147], v[128:131], a[128:131], v[144:147]
    v_mul_f32 v198, v198, v212
    v_mul_f32 v199, v199, v212
    v_cvt_pk_bf16_f32 v195, v198, v199
    v_mfma_f32_16x16x32_bf16 v[148:151], v[128:131], a[132:135], v[148:151]
    s_waitcnt lgkmcnt(1)
    ds_write_b128 v231, v[192:195] offset:5120
    v_mul_f32 v200, v200, v212
    v_mfma_f32_16x16x32_bf16 v[152:155], v[132:135], a[128:131], v[152:155]
    v_mul_f32 v201, v201, v212
    v_cvt_pk_bf16_f32 v196, v200, v201
    v_mul_f32 v202, v202, v212
    v_mfma_f32_16x16x32_bf16 v[156:159], v[132:135], a[132:135], v[156:159]
    s_waitcnt lgkmcnt(1)
    v_mul_f32 v203, v203, v212
    v_cvt_pk_bf16_f32 v197, v202, v203
    v_mul_f32 v204, v204, v212
    v_mfma_f32_16x16x32_bf16 v[144:147], v[136:139], a[136:139], v[144:147]
    v_mul_f32 v205, v205, v212
    v_cvt_pk_bf16_f32 v198, v204, v205
    v_mfma_f32_16x16x32_bf16 v[148:151], v[136:139], a[140:143], v[148:151]
    v_mul_f32 v206, v206, v212
    v_mul_f32 v207, v207, v212
    v_cvt_pk_bf16_f32 v199, v206, v207
    v_mfma_f32_16x16x32_bf16 v[152:155], v[140:143], a[136:139], v[152:155]
    ds_write_b128 v232, v[196:199] offset:5120
    v_mul_f32 v208, v208, v212
    v_mul_f32 v209, v209, v212
    v_mfma_f32_16x16x32_bf16 v[156:159], v[140:143], a[140:143], v[156:159]
    v_cvt_pk_bf16_f32 v200, v208, v209
    v_mul_f32 v144, s18, v144
    v_mul_f32 v145, s18, v145
    v_mul_f32 v146, s18, v146
    v_mul_f32 v147, s18, v147
    v_cvt_pk_bf16_f32 v144, v144, v145
    v_cvt_pk_bf16_f32 v145, v146, v147
    v_mul_f32 v148, s18, v148
    v_mul_f32 v149, s18, v149
    v_mul_f32 v150, s18, v150
    v_mul_f32 v151, s18, v151
    v_cvt_pk_bf16_f32 v148, v148, v149
    v_cvt_pk_bf16_f32 v149, v150, v151
    v_mul_f32 v152, s18, v152
    v_mul_f32 v153, s18, v153
    v_mul_f32 v154, s18, v154
    v_mul_f32 v155, s18, v155
    v_cvt_pk_bf16_f32 v152, v152, v153
    v_cvt_pk_bf16_f32 v153, v154, v155
    v_mul_f32 v156, s18, v156
    v_mul_f32 v157, s18, v157
    ds_write_b32 v233, v200 offset:5120
    ds_write_b64 v35, v[144:145] offset:2560
    ds_write_b64 v35, v[148:149] offset:2816
    ds_write_b64 v35, v[152:153] offset:3840
    v_mul_f32 v158, s18, v158
    v_mul_f32 v159, s18, v159
    v_cvt_pk_bf16_f32 v156, v156, v157
    v_cvt_pk_bf16_f32 v157, v158, v159
    v_mul_f32 v176, v176, v214
    v_mul_f32 v177, v177, v214
    v_cvt_pk_bf16_f32 v176, v176, v177
    v_mul_f32 v178, v178, v214
    v_mul_f32 v179, v179, v214
    v_cvt_pk_bf16_f32 v177, v178, v179
    v_mul_f32 v180, v180, v214
    v_mul_f32 v181, v181, v214
    v_cvt_pk_bf16_f32 v178, v180, v181
    v_mul_f32 v182, v182, v214
    v_mul_f32 v183, v183, v214
    v_cvt_pk_bf16_f32 v179, v182, v183
    ds_write_b64 v35, v[156:157] offset:4096
    ds_read_b128 v[10:13], v237 offset:2560
    ds_read_b64 v[20:21], v238 offset:0
    ds_read_b128 v[14:17], v237 offset:3840
    ds_read_b64 v[24:25], v238 offset:1024
    ds_read_b128 v[60:63], v234 offset:0
    ds_read_b64 v[68:69], v235 offset:0
    ds_read_b128 v[64:67], v234 offset:20480
    ds_read_b64 v[70:71], v235 offset:20480
    ds_read_b64 v[72:73], v235 offset:2560
    ds_read_b64 v[74:75], v235 offset:5120
    ds_write_b128 v231, v[176:179] offset:0
    v_mul_f32 v184, v184, v214
    v_mul_f32 v185, v185, v214
    s_add_u32 s101, s100, 0
    v_cvt_pk_bf16_f32 v180, v184, v185
    v_mul_f32 v186, v186, v214
    v_mul_f32 v187, v187, v214
    v_cvt_pk_bf16_f32 v181, v186, v187
    v_mul_f32 v188, v188, v214
    v_mul_f32 v189, v189, v214
    v_cvt_pk_bf16_f32 v182, v188, v189
    v_mul_f32 v190, v190, v214
    v_mul_f32 v191, v191, v214
    v_cvt_pk_bf16_f32 v183, v190, v191
    v_mul_f32 v162, v162, v214
    v_mul_f32 v163, v163, v214
    v_cvt_pk_bf16_f32 v184, v162, v163
    s_waitcnt lgkmcnt(6)
    v_mfma_f32_32x32x16_bf16 v[44:59], v[60:63], v[10:13], 0
    s_waitcnt lgkmcnt(3)
    ds_read_b128 v[60:63], v234 offset:2560
    buffer_load_dwordx2 a[144:145], v220, s[20:23], s101 offen offset:0 sc1
    v_mfma_f32_32x32x16_bf16 v[44:59], v[68:71], v[20:23], v[44:59]
    buffer_load_dwordx2 a[148:149], v220, s[20:23], s101 offen offset:128 sc1
    v_mfma_f32_32x32x16_bf16 v[96:111], v[64:67], v[10:13], 0
    s_waitcnt lgkmcnt(2)
    buffer_load_dwordx2 a[152:153], v220, s[20:23], s101 offen offset:256 sc1
    ds_read_b128 v[64:67], v234 offset:5120
    v_mfma_f32_32x32x16_bf16 v[96:111], v[68:71], v[18:21], v[96:111]
    buffer_load_dwordx2 a[156:157], v220, s[20:23], s101 offen offset:384 sc1
    buffer_load_dwordx2 a[160:161], v221, s[20:23], s101 offen offset:512 sc1
    s_add_u32 s101, s100, 5248
    s_waitcnt lgkmcnt(1)
    v_mfma_f32_32x32x16_bf16 v[112:127], v[60:63], v[10:13], 0
    ds_read_b128 v[60:63], v234 offset:7680
    ds_read_b64 v[68:69], v235 offset:7680
    buffer_load_dwordx2 a[146:147], v220, s[20:23], s101 offen offset:0 sc1
    v_mfma_f32_32x32x16_bf16 v[112:127], v[72:75], v[20:23], v[112:127]
    ds_write_b128 v232, v[180:183] offset:0
    buffer_load_dwordx2 a[150:151], v220, s[20:23], s101 offen offset:128 sc1
    ds_write_b32 v233, v184 offset:0
    s_waitcnt lgkmcnt(4)
    v_mfma_f32_32x32x16_bf16 v[128:143], v[64:67], v[10:13], 0
    ds_read_b128 v[64:67], v234 offset:10240
    buffer_load_dwordx2 a[154:155], v220, s[20:23], s101 offen offset:256 sc1
    ds_read_b64 v[70:71], v235 offset:10240
    v_cndmask_b32 v96, v44, v96, s[64:65]
    v_mfma_f32_32x32x16_bf16 v[128:143], v[72:75], v[18:21], v[128:143]
    buffer_load_dwordx2 a[158:159], v220, s[20:23], s101 offen offset:384 sc1
    v_cndmask_b32 v97, v45, v97, s[66:67]
    v_cndmask_b32 v98, v46, v98, s[68:69]
    v_cndmask_b32 v99, v47, v99, s[70:71]
    v_cndmask_b32 v100, v48, v100, s[72:73]
    v_cndmask_b32 v101, v49, v101, s[74:75]
    v_cndmask_b32 v102, v50, v102, s[76:77]
    v_cndmask_b32 v103, v51, v103, s[78:79]
    v_cndmask_b32 v104, v52, v104, s[80:81]
    v_cndmask_b32 v105, v53, v105, s[82:83]
    v_cndmask_b32 v106, v54, v106, s[84:85]
    v_cndmask_b32 v107, v55, v107, s[86:87]
    v_cndmask_b32 v108, v56, v108, s[88:89]
    v_cndmask_b32 v109, v57, v109, s[90:91]
    v_cndmask_b32 v110, v58, v110, s[92:93]
    v_cndmask_b32 v111, v59, v111, s[94:95]
    s_waitcnt lgkmcnt(5)
    v_mfma_f32_32x32x16_bf16 v[144:159], v[60:63], v[10:13], 0
    s_waitcnt lgkmcnt(0)
    buffer_load_dwordx2 a[162:163], v221, s[20:23], s101 offen offset:512 sc1
    s_add_u32 s101, s100, 0
    ds_read_b128 v[60:63], v234 offset:12800
    ds_read_b64 v[72:73], v235 offset:12800
    buffer_load_dwordx4 a[164:167], v219, s[20:23], s101 offen offset:0 sc1
    s_add_u32 s101, s100, 20992
    v_mfma_f32_32x32x16_bf16 v[144:159], v[68:71], v[20:23], v[144:159]
    v_max_f32 v92, v96, v97
    v_max_f32 v93, v98, v99
    v_max3_f32 v92, v92, v100, v101
    v_max3_f32 v93, v93, v102, v103
    v_max3_f32 v92, v92, v104, v105
    v_max3_f32 v93, v93, v106, v107
    v_max3_f32 v92, v92, v108, v109
    v_max3_f32 v93, v93, v110, v111
    v_mfma_f32_32x32x16_bf16 v[160:175], v[64:67], v[10:13], 0
    buffer_load_dwordx4 a[168:171], v219, s[20:23], s101 offen offset:0 sc1
    s_add_u32 s101, s100, 5248
    ds_read_b128 v[64:67], v234 offset:15360
    ds_read_b64 v[74:75], v235 offset:15360
    v_max3_f32 v92, v92, v112, v113
    v_mfma_f32_32x32x16_bf16 v[160:175], v[68:71], v[18:21], v[160:175]
    s_waitcnt lgkmcnt(3)
    v_max3_f32 v93, v93, v114, v115
    v_max3_f32 v92, v92, v116, v117
    v_max3_f32 v93, v93, v118, v119
    v_max3_f32 v92, v92, v120, v121
    v_max3_f32 v93, v93, v122, v123
    v_max3_f32 v92, v92, v124, v125
    v_max3_f32 v93, v93, v126, v127
    v_mfma_f32_32x32x16_bf16 v[176:191], v[60:63], v[10:13], 0
    buffer_load_dwordx4 a[172:175], v219, s[20:23], s101 offen offset:0 sc1
    s_add_u32 s101, s100, 26240
    ds_read_b128 v[60:63], v234 offset:17920
    ds_read_b64 v[68:69], v235 offset:17920
    v_max3_f32 v92, v92, v128, v129
    v_max3_f32 v93, v93, v130, v131
    v_max3_f32 v92, v92, v132, v133
    v_max3_f32 v93, v93, v134, v135
    v_max3_f32 v92, v92, v136, v137
    v_max3_f32 v93, v93, v138, v139
    v_max3_f32 v92, v92, v140, v141
    v_max3_f32 v93, v93, v142, v143
    v_max3_f32 v92, v92, v144, v145
    v_max3_f32 v93, v93, v146, v147
    v_max3_f32 v92, v92, v148, v149
    v_max3_f32 v93, v93, v150, v151
    s_waitcnt lgkmcnt(2)
    v_mfma_f32_32x32x16_bf16 v[176:191], v[72:75], v[20:23], v[176:191]
    buffer_load_dwordx4 a[176:179], v219, s[20:23], s101 offen offset:0 sc1
    s_add_u32 s101, s100, 5248
    v_max3_f32 v92, v92, v152, v153
    v_max3_f32 v93, v93, v154, v155
    v_max3_f32 v92, v92, v156, v157
    v_mfma_f32_32x32x16_bf16 v[192:207], v[64:67], v[10:13], 0
    buffer_load_dwordx4 a[180:183], v219, s[20:23], s101 offen offset:256 sc1
    s_add_u32 s101, s100, 26240
    v_mfma_f32_32x32x16_bf16 v[192:207], v[72:75], v[18:21], v[192:207]
    v_max3_f32 v93, v93, v158, v159
    v_max3_f32 v92, v92, v160, v161
    v_max3_f32 v93, v93, v162, v163
    v_max3_f32 v92, v92, v164, v165
    v_max3_f32 v93, v93, v166, v167
    v_max3_f32 v92, v92, v168, v169
    v_max3_f32 v93, v93, v170, v171
    v_max3_f32 v92, v92, v172, v173
    v_max3_f32 v93, v93, v174, v175
    v_max3_f32 v92, v92, v176, v177
    v_max3_f32 v93, v93, v178, v179
    v_max3_f32 v92, v92, v180, v181
    v_max3_f32 v93, v93, v182, v183
    v_max3_f32 v92, v92, v184, v185
    buffer_load_dwordx4 a[184:187], v219, s[20:23], s101 offen offset:256 sc1
    s_add_u32 s101, s100, 0
    v_max3_f32 v93, v93, v186, v187
    v_max3_f32 v92, v92, v188, v189
    v_max3_f32 v93, v93, v190, v191
    v_max3_f32 v92, v92, v192, v193
    buffer_load_dwordx4 a[188:191], v219, s[20:23], s101 offen offset:256 sc1
    s_add_u32 s101, s100, 20992
    v_max3_f32 v93, v93, v194, v195
    v_max3_f32 v92, v92, v196, v197
    v_max3_f32 v93, v93, v198, v199
    v_max3_f32 v92, v92, v200, v201
    buffer_load_dwordx4 a[192:195], v219, s[20:23], s101 offen offset:256 sc1
    s_waitcnt lgkmcnt(1)
    v_mfma_f32_32x32x16_bf16 v[208:223], v[60:63], v[10:13], 0
    s_waitcnt lgkmcnt(0)
    ds_read_b128 v[60:63], v234 offset:1280
    v_max3_f32 v93, v93, v202, v203
    v_mfma_f32_32x32x16_bf16 v[208:223], v[68:71], v[20:23], v[208:223]
    ds_read_b64 v[68:69], v235 offset:1280
    ds_read_b128 v[64:67], v234 offset:21760
    ds_read_b64 v[70:71], v235 offset:21760
    ds_read_b64_tr_b16 v[76:77], v227 offset:0
    ds_read_b64_tr_b16 v[78:79], v228 offset:0
    ds_read_b64_tr_b16 v[80:81], v229 offset:0
    ds_read_b64_tr_b16 v[82:83], v230 offset:0
    ds_read_b64_tr_b16 v[84:85], v227 offset:20480
    ds_read_b64_tr_b16 v[86:87], v228 offset:20480
    ds_read_b64_tr_b16 v[88:89], v229 offset:20480
    ds_read_b64_tr_b16 v[90:91], v230 offset:20480
    v_max3_f32 v92, v92, v204, v205
    v_max3_f32 v93, v93, v206, v207
    v_max3_f32 v92, v92, v208, v209
    v_max3_f32 v93, v93, v210, v211
    v_max3_f32 v92, v92, v212, v213
    v_max3_f32 v93, v93, v214, v215
    v_max3_f32 v92, v92, v216, v217
    v_max3_f32 v93, v93, v218, v219
    v_max3_f32 v92, v92, v220, v221
    v_max3_f32 v93, v93, v222, v223
    s_waitcnt lgkmcnt(11)
    v_mfma_f32_32x32x16_bf16 v[44:59], v[60:63], v[14:17], 0
    s_waitcnt lgkmcnt(8)
    v_max_f32 v92, v92, v93
    v_mov_b32 v93, v92
    s_nop 1
    v_permlane32_swap_b32 v92, v93
    v_mfma_f32_32x32x16_bf16 v[44:59], v[68:71], v[24:27], v[44:59]
    v_max_f32 v92, v92, v93
    v_and_b32 v93, 0xffff0000, v92
    v_sub_f32 v92, v93, v92
    v_cvt_pk_bf16_f32 v248, -v93, v92
    s_mov_b32 s62, 262144
    s_nop 0
    v_mfma_f32_32x32x16_bf16 v[96:111], v[250:253], v[248:251], v[96:111]
    buffer_load_dwordx2 v[244:245], v242, s[20:23], s62 offen sc1
    s_add_u32 s101, s100, 0
    v_mfma_f32_32x32x16_bf16 v[112:127], v[250:253], v[248:251], v[112:127]
    buffer_load_dwordx4 a[196:199], v254, s[20:23], s101 offen offset:0 sc1
    v_mfma_f32_32x32x16_bf16 v[128:143], v[250:253], v[248:251], v[128:143]
    s_nop 6
    v_exp_f32 v96, v96
    v_exp_f32 v97, v97
    s_nop 0
    v_cvt_pk_bf16_f32 v96, v96, v97
    v_exp_f32 v98, v98
    v_exp_f32 v99, v99
    s_nop 0
    v_cvt_pk_bf16_f32 v97, v98, v99
    v_exp_f32 v100, v100
    v_exp_f32 v101, v101
    v_exp_f32 v102, v102
    v_exp_f32 v103, v103
    v_cvt_pk_bf16_f32 v98, v100, v101
    v_exp_f32 v104, v104
    v_exp_f32 v105, v105
    v_cvt_pk_bf16_f32 v99, v102, v103
    v_exp_f32 v106, v106
    v_exp_f32 v107, v107
    v_cvt_pk_bf16_f32 v100, v104, v105
    v_exp_f32 v108, v108
    v_exp_f32 v109, v109
    v_cvt_pk_bf16_f32 v101, v106, v107
    v_exp_f32 v110, v110
    v_exp_f32 v111, v111
    v_cvt_pk_bf16_f32 v102, v108, v109
    v_cvt_pk_bf16_f32 v103, v110, v111
    v_and_b32 v104, v2, v96
    v_and_b32 v105, v3, v97
    v_and_b32 v106, v4, v98
    v_and_b32 v107, v5, v99
    v_and_b32 v108, v6, v100
    v_and_b32 v109, v7, v101
    v_and_b32 v110, v8, v102
    v_and_b32 v111, v9, v103
    v_xor_b32 v96, v104, v96
    v_xor_b32 v97, v105, v97
    v_xor_b32 v98, v106, v98
    v_xor_b32 v99, v107, v99
    v_xor_b32 v100, v108, v100
    v_xor_b32 v101, v109, v101
    v_xor_b32 v102, v110, v102
    v_xor_b32 v103, v111, v103
    v_exp_f32 v112, v112
    v_mfma_f32_32x32x16_bf16 v[144:159], v[250:253], v[248:251], v[144:159]
    s_waitcnt lgkmcnt(4)
    buffer_load_dwordx4 a[200:203], v254, s[20:23], s101 offen offset:1024 sc1
    v_exp_f32 v113, v113
    v_exp_f32 v114, v114
    v_cvt_pk_bf16_f32 v112, v112, v113
    v_mfma_f32_32x32x16_bf16 v[28:43], v[76:79], v[96:99], 0
    v_exp_f32 v115, v115
    v_exp_f32 v116, v116
    v_exp_f32 v117, v117
    v_mfma_f32_32x32x16_bf16 v[28:43], v[80:83], v[100:103], v[28:43]
    s_waitcnt lgkmcnt(2)
    buffer_load_dwordx4 a[204:207], v254, s[20:23], s101 offen offset:2048 sc1
    ds_read_b64_tr_b16 v[76:77], v227 offset:2560
    ds_read_b64_tr_b16 v[78:79], v228 offset:2560
    ds_read_b64_tr_b16 v[80:81], v229 offset:2560
    v_cvt_pk_bf16_f32 v113, v114, v115
    v_exp_f32 v118, v118
    v_exp_f32 v119, v119
    v_mfma_f32_32x32x16_bf16 v[28:43], v[84:87], v[104:107], v[28:43]
    s_waitcnt lgkmcnt(3)
    ds_read_b64_tr_b16 v[82:83], v230 offset:2560
    v_cvt_pk_bf16_f32 v114, v116, v117
    v_exp_f32 v120, v120
    v_exp_f32 v121, v121
    v_mfma_f32_32x32x16_bf16 v[28:43], v[88:91], v[108:111], v[28:43]
    ds_read_b64_tr_b16 v[84:85], v227 offset:5120
    v_cvt_pk_bf16_f32 v115, v118, v119
    v_exp_f32 v122, v122
    v_exp_f32 v123, v123
    v_cvt_pk_bf16_f32 v116, v120, v121
    v_exp_f32 v124, v124
    v_mfma_f32_32x32x16_bf16 v[96:111], v[64:67], v[14:17], 0
    ds_read_b64_tr_b16 v[86:87], v228 offset:5120
    ds_read_b64_tr_b16 v[88:89], v229 offset:5120
    ds_read_b64_tr_b16 v[90:91], v230 offset:5120
    v_exp_f32 v125, v125
    v_cvt_pk_bf16_f32 v117, v122, v123
    v_mfma_f32_32x32x16_bf16 v[96:111], v[68:71], v[22:25], v[96:111]
    v_exp_f32 v126, v126
    v_exp_f32 v127, v127
    v_cvt_pk_bf16_f32 v118, v124, v125
    v_cvt_pk_bf16_f32 v119, v126, v127
    v_add_u32 v10, 162432, v224
    v_add_u32 v95, s11, v224
    v_exp_f32 v128, v128
    v_mfma_f32_32x32x16_bf16 v[160:175], v[250:253], v[248:251], v[160:175]
    s_waitcnt lgkmcnt(6)
    ds_read_b128 v[60:63], v234 offset:3840
    ds_read_b64 v[72:73], v235 offset:3840
    buffer_load_dwordx4 a[208:211], v254, s[20:23], s101 offen offset:3072 sc1
    s_add_u32 s101, s100, 20992
    ds_read_b128 v[10:13], v10
    v_exp_f32 v129, v129
    v_exp_f32 v130, v130
    v_mfma_f32_32x32x16_bf16 v[28:43], v[76:79], v[112:115], v[28:43]
    s_waitcnt lgkmcnt(7)
    v_exp_f32 v131, v131
    v_cvt_pk_bf16_f32 v128, v128, v129
    v_exp_f32 v132, v132
    v_cvt_pk_bf16_f32 v129, v130, v131
    v_mfma_f32_32x32x16_bf16 v[28:43], v[80:83], v[116:119], v[28:43]
    buffer_load_dwordx4 a[212:215], v254, s[20:23], s101 offen offset:0 sc1
    v_exp_f32 v133, v133
    v_exp_f32 v134, v134
    v_exp_f32 v135, v135
    v_cvt_pk_bf16_f32 v130, v132, v133
    v_exp_f32 v136, v136
    v_exp_f32 v137, v137
    v_cvt_pk_bf16_f32 v131, v134, v135
    v_exp_f32 v138, v138
    v_exp_f32 v139, v139
    v_cvt_pk_bf16_f32 v132, v136, v137
    s_waitcnt lgkmcnt(2)
    v_mfma_f32_32x32x16_bf16 v[112:127], v[60:63], v[14:17], 0
    s_waitcnt lgkmcnt(1)
    buffer_load_dwordx4 a[216:219], v254, s[20:23], s101 offen offset:1024 sc1
    ds_read_b64_tr_b16 v[76:77], v227 offset:7680
    ds_read_b64_tr_b16 v[78:79], v228 offset:7680
    ds_read_b64_tr_b16 v[80:81], v229 offset:7680
    ds_read_b64_tr_b16 v[82:83], v230 offset:7680
    v_exp_f32 v140, v140
    v_exp_f32 v141, v141
    v_mfma_f32_32x32x16_bf16 v[112:127], v[72:75], v[24:27], v[112:127]
    v_cvt_pk_bf16_f32 v133, v138, v139
    v_exp_f32 v142, v142
    v_exp_f32 v143, v143
    v_cvt_pk_bf16_f32 v134, v140, v141
    v_cvt_pk_bf16_f32 v135, v142, v143
    v_and_b32 v94, 31, v0
    v_and_b32 v232, 19, v0
    ds_read_b128 v[64:67], v234 offset:6400
    ds_read_b64 v[74:75], v235 offset:6400
    s_waitcnt vmcnt(6)
    v_cmp_ne_u64 vcc, s[58:59], v[244:245]
    s_cbranch_vccz .Lqf2
    s_mov_b32 s62, 262144
    s_mov_b32 s63, 300000
.Lpf2:
    buffer_load_dwordx2 v[244:245], v242, s[20:23], s62 offen sc1
    s_waitcnt vmcnt(0)
    v_cmp_ne_u64 vcc, s[58:59], v[244:245]
    s_sub_u32 s63, s63, 1
    s_cbranch_scc1 .Lend
    s_cbranch_vccnz .Lpf2
.Lqf2:
    v_min_u32 v245, 704, v224
    v_cmp_gt_u32 vcc, 16, v94
    v_exp_f32 v144, v144
    s_nop 0
    v_cndmask_b32 v94, v232, v94, vcc
    v_bfe_u32 v232, v0, 5, 1
    v_mul_u32_u24 v231, 320, v232
    v_lshl_add_u32 v231, v94, 4, v231
    v_add_u32 v231, 156288, v231
    v_lshl_add_u32 v94, v232, 10, v94
    v_lshlrev_b32 v94, 2, v94
    v_add_u32 v94, 156928, v94
    v_mul_u32_u24 v232, 3840, v232
    v_add_u32 v232, v232, v233
    v_mfma_f32_32x32x16_bf16 v[176:191], v[250:253], v[248:251], v[176:191]
    buffer_load_dwordx4 a[64:67], v245, s[20:23], s6 offen offset:0 sc1
    v_exp_f32 v145, v145
    v_exp_f32 v146, v146
    v_cvt_pk_bf16_f32 v144, v144, v145
    v_mfma_f32_32x32x16_bf16 v[28:43], v[84:87], v[128:131], v[28:43]
    v_exp_f32 v147, v147
    v_exp_f32 v148, v148
    v_exp_f32 v149, v149
    v_mfma_f32_32x32x16_bf16 v[28:43], v[88:91], v[132:135], v[28:43]
    buffer_load_dwordx4 a[68:71], v245, s[20:23], s6 offen offset:768 sc1
    v_cvt_pk_bf16_f32 v145, v146, v147
    v_exp_f32 v150, v150
    v_exp_f32 v151, v151
    v_cvt_pk_bf16_f32 v146, v148, v149
    v_exp_f32 v152, v152
    v_exp_f32 v153, v153
    v_cvt_pk_bf16_f32 v147, v150, v151
    v_exp_f32 v154, v154
    v_exp_f32 v155, v155
    v_cvt_pk_bf16_f32 v148, v152, v153
    v_exp_f32 v156, v156
    v_exp_f32 v157, v157
    s_waitcnt lgkmcnt(1)
    v_mfma_f32_32x32x16_bf16 v[128:143], v[64:67], v[14:17], 0
    s_waitcnt lgkmcnt(0)
    buffer_load_dwordx4 a[72:75], v245, s[20:23], s6 offen offset:1536 sc1
    ds_read_b64_tr_b16 v[84:85], v227 offset:10240
    ds_read_b64_tr_b16 v[86:87], v228 offset:10240
    ds_read_b64_tr_b16 v[88:89], v229 offset:10240
    ds_read_b64_tr_b16 v[90:91], v230 offset:10240
    v_cvt_pk_bf16_f32 v149, v154, v155
    v_exp_f32 v158, v158
    v_exp_f32 v159, v159
    v_mfma_f32_32x32x16_bf16 v[128:143], v[72:75], v[22:25], v[128:143]
    buffer_load_dwordx4 a[76:79], v245, s[20:23], s6 offen offset:2304 sc1
    v_cvt_pk_bf16_f32 v150, v156, v157
    v_cvt_pk_bf16_f32 v151, v158, v159
    v_cndmask_b32 v96, v44, v96, s[64:65]
    v_cndmask_b32 v97, v45, v97, s[66:67]
    v_cndmask_b32 v98, v46, v98, s[68:69]
    v_cndmask_b32 v99, v47, v99, s[70:71]
    v_cndmask_b32 v100, v48, v100, s[72:73]
    v_cndmask_b32 v101, v49, v101, s[74:75]
    v_cndmask_b32 v102, v50, v102, s[76:77]
    v_cndmask_b32 v103, v51, v103, s[78:79]
    v_cndmask_b32 v104, v52, v104, s[80:81]
    v_cndmask_b32 v105, v53, v105, s[82:83]
    v_cndmask_b32 v106, v54, v106, s[84:85]
    v_cndmask_b32 v107, v55, v107, s[86:87]
    v_cndmask_b32 v108, v56, v108, s[88:89]
    v_cndmask_b32 v109, v57, v109, s[90:91]
    v_cndmask_b32 v110, v58, v110, s[92:93]
    v_cndmask_b32 v111, v59, v111, s[94:95]
    v_exp_f32 v160, v160
    v_mfma_f32_32x32x16_bf16 v[192:207], v[250:253], v[248:251], v[192:207]
    ds_read_b128 v[60:63], v234 offset:8960
    ds_read_b64 v[68:69], v235 offset:8960
    buffer_load_dwordx4 a[80:83], v245, s[20:23], s6 offen offset:3072 sc1
    v_exp_f32 v161, v161
    v_exp_f32 v162, v162
    v_mfma_f32_32x32x16_bf16 v[28:43], v[76:79], v[144:147], v[28:43]
    v_exp_f32 v163, v163
    v_cvt_pk_bf16_f32 v160, v160, v161
    v_exp_f32 v164, v164
    v_cvt_pk_bf16_f32 v161, v162, v163
    v_mfma_f32_32x32x16_bf16 v[28:43], v[80:83], v[148:151], v[28:43]
    buffer_load_dwordx4 a[84:87], v245, s[20:23], s6 offen offset:3840 sc1
    s_add_u32 s6, s6, 4608
    v_exp_f32 v165, v165
    v_exp_f32 v166, v166
    v_exp_f32 v167, v167
    v_cvt_pk_bf16_f32 v162, v164, v165
    v_exp_f32 v168, v168
    v_exp_f32 v169, v169
    v_cvt_pk_bf16_f32 v163, v166, v167
    v_exp_f32 v170, v170
    s_waitcnt lgkmcnt(1)
    v_mfma_f32_32x32x16_bf16 v[144:159], v[60:63], v[14:17], 0
    s_waitcnt lgkmcnt(0)
    buffer_load_dwordx4 a[88:91], v245, s[20:23], s6 offen offset:0 sc1
    ds_read_b64_tr_b16 v[76:77], v227 offset:12800
    ds_read_b64_tr_b16 v[78:79], v228 offset:12800
    ds_read_b64_tr_b16 v[80:81], v229 offset:12800
    ds_read_b64_tr_b16 v[82:83], v230 offset:12800
    v_exp_f32 v171, v171
    v_cvt_pk_bf16_f32 v164, v168, v169
    v_exp_f32 v172, v172
    v_mfma_f32_32x32x16_bf16 v[144:159], v[68:71], v[24:27], v[144:159]
    buffer_load_dwordx4 a[92:95], v245, s[20:23], s6 offen offset:768 sc1
    v_exp_f32 v173, v173
    v_cvt_pk_bf16_f32 v165, v170, v171
    v_exp_f32 v174, v174
    v_exp_f32 v175, v175
    v_cvt_pk_bf16_f32 v166, v172, v173
    v_cvt_pk_bf16_f32 v167, v174, v175
    v_max_f32 v92, v96, v97
    v_max_f32 v93, v98, v99
    v_max3_f32 v92, v92, v100, v101
    v_max3_f32 v93, v93, v102, v103
    v_max3_f32 v92, v92, v104, v105
    v_max3_f32 v93, v93, v106, v107
    v_max3_f32 v92, v92, v108, v109
    v_max3_f32 v93, v93, v110, v111
    v_exp_f32 v176, v176
    v_mfma_f32_32x32x16_bf16 v[208:223], v[250:253], v[248:251], v[208:223]
    ds_read_b128 v[64:67], v234 offset:11520
    ds_read_b64 v[70:71], v235 offset:11520
    buffer_load_dwordx4 a[96:99], v245, s[20:23], s6 offen offset:1536 sc1
    v_exp_f32 v177, v177
    v_exp_f32 v178, v178
    v_mfma_f32_32x32x16_bf16 v[28:43], v[84:87], v[160:163], v[28:43]
    v_exp_f32 v179, v179
    v_cvt_pk_bf16_f32 v176, v176, v177
    v_exp_f32 v180, v180
    v_cvt_pk_bf16_f32 v177, v178, v179
    v_mfma_f32_32x32x16_bf16 v[28:43], v[88:91], v[164:167], v[28:43]
    buffer_load_dwordx4 a[100:103], v245, s[20:23], s6 offen offset:2304 sc1
    v_exp_f32 v181, v181
    v_exp_f32 v182, v182
    v_exp_f32 v183, v183
    v_cvt_pk_bf16_f32 v178, v180, v181
    v_exp_f32 v184, v184
    v_exp_f32 v185, v185
    v_cvt_pk_bf16_f32 v179, v182, v183
    v_exp_f32 v186, v186
    s_waitcnt lgkmcnt(1)
    v_mfma_f32_32x32x16_bf16 v[160:175], v[64:67], v[14:17], 0
    s_waitcnt lgkmcnt(0)
    buffer_load_dwordx4 a[104:107], v245, s[20:23], s6 offen offset:3072 sc1
    ds_read_b64_tr_b16 v[84:85], v227 offset:15360
    ds_read_b64_tr_b16 v[86:87], v228 offset:15360
    ds_read_b64_tr_b16 v[88:89], v229 offset:15360
    ds_read_b64_tr_b16 v[90:91], v230 offset:15360
    v_exp_f32 v187, v187
    v_cvt_pk_bf16_f32 v180, v184, v185
    v_exp_f32 v188, v188
    v_mfma_f32_32x32x16_bf16 v[160:175], v[68:71], v[22:25], v[160:175]
    buffer_load_dwordx4 a[108:111], v245, s[20:23], s6 offen offset:3840 sc1
    s_add_u32 s6, s6, 4608
    v_exp_f32 v189, v189
    v_cvt_pk_bf16_f32 v181, v186, v187
    v_exp_f32 v190, v190
    v_exp_f32 v191, v191
    v_cvt_pk_bf16_f32 v182, v188, v189
    v_cvt_pk_bf16_f32 v183, v190, v191
    v_max3_f32 v92, v92, v112, v113
    v_max3_f32 v93, v93, v114, v115
    v_max3_f32 v92, v92, v116, v117
    v_max3_f32 v93, v93, v118, v119
    v_max3_f32 v92, v92, v120, v121
    v_max3_f32 v93, v93, v122, v123
    v_max3_f32 v92, v92, v124, v125
    v_max3_f32 v93, v93, v126, v127
    v_exp_f32 v192, v192
    v_mfma_f32_32x32x16_bf16 v[28:43], v[76:79], v[176:179], v[28:43]
    ds_read_b128 v[60:63], v234 offset:14080
    ds_read_b64 v[72:73], v235 offset:14080
    buffer_load_dwordx4 a[112:115], v245, s[20:23], s6 offen offset:0 sc1
    v_exp_f32 v193, v193
    v_exp_f32 v194, v194
    v_mfma_f32_32x32x16_bf16 v[28:43], v[80:83], v[180:183], v[28:43]
    v_exp_f32 v195, v195
    v_cvt_pk_bf16_f32 v192, v192, v193
    v_exp_f32 v196, v196
    v_exp_f32 v197, v197
    v_cvt_pk_bf16_f32 v193, v194, v195
    v_exp_f32 v198, v198
    v_exp_f32 v199, v199
    v_cvt_pk_bf16_f32 v194, v196, v197
    v_exp_f32 v200, v200
    v_exp_f32 v201, v201
    v_cvt_pk_bf16_f32 v195, v198, v199
    v_exp_f32 v202, v202
    v_exp_f32 v203, v203
    v_cvt_pk_bf16_f32 v196, v200, v201
    s_waitcnt lgkmcnt(1)
    v_mfma_f32_32x32x16_bf16 v[176:191], v[60:63], v[14:17], 0
    s_waitcnt lgkmcnt(0)
    buffer_load_dwordx4 a[116:119], v245, s[20:23], s6 offen offset:768 sc1
    ds_read_b64_tr_b16 v[76:77], v227 offset:17920
    ds_read_b64_tr_b16 v[78:79], v228 offset:17920
    ds_read_b64_tr_b16 v[80:81], v229 offset:17920
    ds_read_b64_tr_b16 v[82:83], v230 offset:17920
    v_exp_f32 v204, v204
    v_mfma_f32_32x32x16_bf16 v[176:191], v[72:75], v[24:27], v[176:191]
    v_exp_f32 v205, v205
    v_cvt_pk_bf16_f32 v197, v202, v203
    v_exp_f32 v206, v206
    v_exp_f32 v207, v207
    v_cvt_pk_bf16_f32 v198, v204, v205
    v_cvt_pk_bf16_f32 v199, v206, v207
    v_max3_f32 v92, v92, v128, v129
    v_max3_f32 v93, v93, v130, v131
    v_max3_f32 v92, v92, v132, v133
    v_max3_f32 v93, v93, v134, v135
    v_max3_f32 v92, v92, v136, v137
    v_max3_f32 v93, v93, v138, v139
    v_max3_f32 v92, v92, v140, v141
    v_max3_f32 v93, v93, v142, v143
    v_exp_f32 v208, v208
    v_mfma_f32_32x32x16_bf16 v[28:43], v[84:87], v[192:195], v[28:43]
    buffer_load_dwordx4 a[120:123], v245, s[20:23], s6 offen offset:1536 sc1
    ds_read_b128 v[64:67], v234 offset:16640
    ds_read_b64 v[74:75], v235 offset:16640
    v_exp_f32 v209, v209
    v_exp_f32 v210, v210
    v_exp_f32 v211, v211
    v_mfma_f32_32x32x16_bf16 v[28:43], v[88:91], v[196:199], v[28:43]
    buffer_load_dwordx4 a[124:127], v245, s[20:23], s6 offen offset:2304 sc1
    v_cvt_pk_bf16_f32 v208, v208, v209
    v_exp_f32 v212, v212
    v_exp_f32 v213, v213
    v_cvt_pk_bf16_f32 v209, v210, v211
    v_exp_f32 v214, v214
    v_exp_f32 v215, v215
    v_cvt_pk_bf16_f32 v210, v212, v213
    v_exp_f32 v216, v216
    v_exp_f32 v217, v217
    v_cvt_pk_bf16_f32 v211, v214, v215
    v_exp_f32 v218, v218
    s_waitcnt lgkmcnt(1)
    v_mfma_f32_32x32x16_bf16 v[192:207], v[64:67], v[14:17], 0
    s_waitcnt lgkmcnt(0)
    buffer_load_dwordx4 a[220:223], v254, s[20:23], s101 offen offset:2048 sc1
    ds_read_b128 v[60:63], v234 offset:19200
    v_exp_f32 v219, v219
    v_cvt_pk_bf16_f32 v212, v216, v217
    v_mfma_f32_32x32x16_bf16 v[192:207], v[72:75], v[22:25], v[192:207]
    v_exp_f32 v220, v220
    v_exp_f32 v221, v221
    v_cvt_pk_bf16_f32 v213, v218, v219
    v_exp_f32 v222, v222
    v_exp_f32 v223, v223
    v_cvt_pk_bf16_f32 v214, v220, v221
    v_cvt_pk_bf16_f32 v215, v222, v223
    v_max3_f32 v92, v92, v144, v145
    v_max3_f32 v93, v93, v146, v147
    v_max3_f32 v92, v92, v148, v149
    v_max3_f32 v93, v93, v150, v151
    v_max3_f32 v92, v92, v152, v153
    v_max3_f32 v93, v93, v154, v155
    v_max3_f32 v92, v92, v156, v157
    v_max3_f32 v93, v93, v158, v159
    v_max3_f32 v92, v92, v160, v161
    v_mfma_f32_32x32x16_bf16 v[28:43], v[76:79], v[208:211], v[28:43]
    s_waitcnt lgkmcnt(0)
    buffer_load_dwordx4 a[224:227], v254, s[20:23], s101 offen offset:3072 sc1
    s_add_u32 s101, s100, 5248
    ds_read_b64 v[68:69], v235 offset:19200
    v_max3_f32 v93, v93, v162, v163
    v_max3_f32 v92, v92, v164, v165
    v_max3_f32 v93, v93, v166, v167
    v_mfma_f32_32x32x16_bf16 v[28:43], v[80:83], v[212:215], v[28:43]
    buffer_load_dwordx4 a[228:231], v254, s[20:23], s101 offen offset:0 sc1
    v_mfma_f32_32x32x16_bf16 v[208:223], v[60:63], v[14:17], 0
    v_max3_f32 v92, v92, v168, v169
    v_max3_f32 v93, v93, v170, v171
    v_max3_f32 v92, v92, v172, v173
    v_max3_f32 v93, v93, v174, v175
    v_max3_f32 v92, v92, v176, v177
    v_max3_f32 v93, v93, v178, v179
    v_max3_f32 v92, v92, v180, v181
    v_max3_f32 v93, v93, v182, v183
    v_max3_f32 v92, v92, v184, v185
    v_max3_f32 v93, v93, v186, v187
    v_max3_f32 v92, v92, v188, v189
    v_max3_f32 v93, v93, v190, v191
    v_max3_f32 v92, v92, v192, v193
    v_max3_f32 v93, v93, v194, v195
    s_waitcnt lgkmcnt(0)
    v_mfma_f32_32x32x16_bf16 v[208:223], v[68:71], v[24:27], v[208:223]
    buffer_load_dwordx4 a[232:235], v254, s[20:23], s101 offen offset:1024 sc1
    ds_read_b64_tr_b16 v[76:77], v227 offset:1280
    ds_read_b64_tr_b16 v[78:79], v228 offset:1280
    ds_read_b64_tr_b16 v[80:81], v229 offset:1280
    ds_read_b64_tr_b16 v[82:83], v230 offset:1280
    ds_read_b64_tr_b16 v[84:85], v227 offset:21760
    ds_read_b64_tr_b16 v[86:87], v228 offset:21760
    ds_read_b64_tr_b16 v[88:89], v229 offset:21760
    ds_read_b64_tr_b16 v[90:91], v230 offset:21760
    buffer_load_dwordx4 a[236:239], v254, s[20:23], s101 offen offset:2048 sc1
    v_max3_f32 v92, v92, v196, v197
    v_max3_f32 v93, v93, v198, v199
    v_max3_f32 v92, v92, v200, v201
    v_max3_f32 v93, v93, v202, v203
    v_max3_f32 v92, v92, v204, v205
    v_max3_f32 v93, v93, v206, v207
    v_max3_f32 v92, v92, v208, v209
    v_max3_f32 v93, v93, v210, v211
    v_max3_f32 v92, v92, v212, v213
    v_max3_f32 v93, v93, v214, v215
    v_max3_f32 v92, v92, v216, v217
    v_max3_f32 v93, v93, v218, v219
    v_max3_f32 v92, v92, v220, v221
    v_max3_f32 v93, v93, v222, v223
    v_max_f32 v92, v92, v93
    v_mov_b32 v93, v92
    v_rcp_f32 v38, v38
    s_nop 0
    v_permlane32_swap_b32 v92, v93
    v_max_f32 v92, v92, v93
    v_and_b32 v93, 0xffff0000, v92
    v_sub_f32 v92, v93, v92
    v_cvt_pk_bf16_f32 v248, -v93, v92
    v_mul_f32 v38, v226, v38
    v_mul_f32 v28, v28, v38
    v_mfma_f32_32x32x16_bf16 v[96:111], v[250:253], v[248:251], v[96:111]
    buffer_load_dwordx4 a[240:243], v254, s[20:23], s101 offen offset:3072 sc1
    s_add_u32 s101, s100, 26240
    v_mul_f32 v29, v29, v38
    v_cvt_pk_bf16_f32 v40, v28, v29
    v_mul_f32 v30, v30, v38
    v_mul_f32 v31, v31, v38
    v_mfma_f32_32x32x16_bf16 v[112:127], v[250:253], v[248:251], v[112:127]
    buffer_load_dwordx4 a[244:247], v254, s[20:23], s101 offen offset:0 sc1
    v_cvt_pk_bf16_f32 v41, v30, v31
    v_mul_f32 v32, v32, v38
    v_mul_f32 v33, v33, v38
    v_cvt_pk_bf16_f32 v42, v32, v33
    v_mul_f32 v34, v34, v38
    v_mul_f32 v35, v35, v38
    v_cvt_pk_bf16_f32 v43, v34, v35
    v_mul_f32 v36, v36, v38
    v_mul_f32 v37, v37, v38
    v_cvt_pk_bf16_f32 v236, v36, v37
    v_exp_f32 v96, v96
    v_mfma_f32_32x32x16_bf16 v[128:143], v[250:253], v[248:251], v[128:143]
    buffer_load_dwordx4 a[248:251], v254, s[20:23], s101 offen offset:1024 sc1
    v_exp_f32 v97, v97
    v_exp_f32 v98, v98
    v_exp_f32 v99, v99
    buffer_load_dwordx4 a[252:255], v254, s[20:23], s101 offen offset:2048 sc1
    v_cvt_pk_bf16_f32 v96, v96, v97
    v_exp_f32 v100, v100
    v_exp_f32 v101, v101
    s_waitcnt vmcnt(24)
    v_mfma_f32_32x32x16_bf16 a[128:143], v[10:13], a[64:67], 0
    v_cvt_pk_bf16_f32 v97, v98, v99
    v_exp_f32 v102, v102
    v_exp_f32 v103, v103
    buffer_store_dwordx4 v[40:43], v240, s[20:23], s16 offen offset:0 sc1
    v_cvt_pk_bf16_f32 v98, v100, v101
    v_exp_f32 v104, v104
    v_exp_f32 v105, v105
    v_cvt_pk_bf16_f32 v99, v102, v103
    s_waitcnt vmcnt(24)
    v_mfma_f32_32x32x16_bf16 a[128:143], v[10:13], a[68:71], a[128:143]
    v_exp_f32 v106, v106
    v_exp_f32 v107, v107
    v_cvt_pk_bf16_f32 v100, v104, v105
    v_exp_f32 v108, v108
    v_exp_f32 v109, v109
    v_cvt_pk_bf16_f32 v101, v106, v107
    v_exp_f32 v110, v110
    s_waitcnt vmcnt(23)
    v_mfma_f32_32x32x16_bf16 a[128:143], v[10:13], a[72:75], a[128:143]
    v_exp_f32 v111, v111
    v_cvt_pk_bf16_f32 v102, v108, v109
    v_cvt_pk_bf16_f32 v103, v110, v111
    v_and_b32 v104, v2, v96
    v_and_b32 v105, v3, v97
    v_and_b32 v106, v4, v98
    s_waitcnt vmcnt(22)
    v_mfma_f32_32x32x16_bf16 a[128:143], v[10:13], a[76:79], a[128:143]
    v_and_b32 v107, v5, v99
    v_and_b32 v108, v6, v100
    v_and_b32 v109, v7, v101
    v_and_b32 v110, v8, v102
    v_and_b32 v111, v9, v103
    v_xor_b32 v96, v104, v96
    v_xor_b32 v97, v105, v97
    v_xor_b32 v98, v106, v98
    v_xor_b32 v99, v107, v99
    v_xor_b32 v100, v108, v100
    v_xor_b32 v101, v109, v101
    v_xor_b32 v102, v110, v102
    v_xor_b32 v103, v111, v103
    v_exp_f32 v112, v112
    v_mfma_f32_32x32x16_bf16 v[144:159], v[250:253], v[248:251], v[144:159]
    s_waitcnt lgkmcnt(4)
    buffer_load_dwordx4 a[0:3], v254, s[20:23], s101 offen offset:3072 sc1
    v_exp_f32 v113, v113
    v_exp_f32 v114, v114
    v_cvt_pk_bf16_f32 v112, v112, v113
    v_mfma_f32_32x32x16_bf16 v[44:59], v[76:79], v[96:99], 0
    s_waitcnt lgkmcnt(2)
    v_exp_f32 v115, v115
    v_exp_f32 v116, v116
    v_exp_f32 v117, v117
    v_mfma_f32_32x32x16_bf16 v[44:59], v[80:83], v[100:103], v[44:59]
    s_waitcnt lgkmcnt(0)
    ds_read_b64_tr_b16 v[76:77], v227 offset:3840
    ds_read_b64_tr_b16 v[78:79], v228 offset:3840
    ds_read_b64_tr_b16 v[80:81], v229 offset:3840
    ds_read_b64_tr_b16 v[82:83], v230 offset:3840
    v_cvt_pk_bf16_f32 v113, v114, v115
    v_cvt_pk_bf16_f32 v114, v116, v117
    v_mfma_f32_32x32x16_bf16 v[44:59], v[84:87], v[104:107], v[44:59]
    v_exp_f32 v118, v118
    v_exp_f32 v119, v119
    v_exp_f32 v120, v120
    v_mfma_f32_32x32x16_bf16 v[44:59], v[88:91], v[108:111], v[44:59]
    ds_read_b64_tr_b16 v[84:85], v227 offset:6400
    ds_read_b64_tr_b16 v[86:87], v228 offset:6400
    v_exp_f32 v121, v121
    v_cvt_pk_bf16_f32 v115, v118, v119
    v_exp_f32 v122, v122
    s_waitcnt vmcnt(22)
    v_mfma_f32_32x32x16_bf16 a[128:143], v[10:13], a[80:83], a[128:143]
    ds_read_b64_tr_b16 v[88:89], v229 offset:6400
    ds_read_b64_tr_b16 v[90:91], v230 offset:6400
    v_exp_f32 v123, v123
    v_cvt_pk_bf16_f32 v116, v120, v121
    s_mov_b32 s62, 393216
    s_waitcnt vmcnt(21)
    v_mfma_f32_32x32x16_bf16 a[128:143], v[10:13], a[84:87], a[128:143]
    s_add_u32 s101, s100, 5248
    v_exp_f32 v124, v124
    v_exp_f32 v125, v125
    v_cvt_pk_bf16_f32 v117, v122, v123
    s_waitcnt vmcnt(20)
    v_mfma_f32_32x32x16_bf16 a[128:143], v[10:13], a[88:91], a[128:143]
    buffer_load_dwordx2 v[244:245], v243, s[20:23], s62 offen sc1
    v_exp_f32 v126, v126
    v_exp_f32 v127, v127
    s_waitcnt vmcnt(20)
    v_mfma_f32_32x32x16_bf16 a[128:143], v[10:13], a[92:95], a[128:143]
    s_waitcnt lgkmcnt(6)
    buffer_load_dwordx4 a[4:7], v254, s[20:23], s101 offen offset:512 sc1
    v_cvt_pk_bf16_f32 v118, v124, v125
    v_cvt_pk_bf16_f32 v119, v126, v127
    v_exp_f32 v128, v128
    v_mfma_f32_32x32x16_bf16 v[160:175], v[250:253], v[248:251], v[160:175]
    s_waitcnt lgkmcnt(4)
    v_exp_f32 v129, v129
    v_exp_f32 v130, v130
    v_exp_f32 v131, v131
    v_mfma_f32_32x32x16_bf16 v[44:59], v[76:79], v[112:115], v[44:59]
    buffer_load_dwordx4 a[8:11], v254, s[20:23], s101 offen offset:1536 sc1
    v_cvt_pk_bf16_f32 v128, v128, v129
    v_exp_f32 v132, v132
    v_exp_f32 v133, v133
    v_mfma_f32_32x32x16_bf16 v[44:59], v[80:83], v[116:119], v[44:59]
    ds_read_b64_tr_b16 v[76:77], v227 offset:8960
    ds_read_b64_tr_b16 v[78:79], v228 offset:8960
    v_cvt_pk_bf16_f32 v129, v130, v131
    v_exp_f32 v134, v134
    v_exp_f32 v135, v135
    v_cvt_pk_bf16_f32 v130, v132, v133
    v_exp_f32 v136, v136
    s_waitcnt vmcnt(21)
    v_mfma_f32_32x32x16_bf16 a[128:143], v[10:13], a[96:99], a[128:143]
    buffer_load_dwordx4 a[12:15], v254, s[20:23], s101 offen offset:2560 sc1
    ds_read_b64_tr_b16 v[80:81], v229 offset:8960
    ds_read_b64_tr_b16 v[82:83], v230 offset:8960
    v_exp_f32 v137, v137
    v_cvt_pk_bf16_f32 v131, v134, v135
    s_waitcnt vmcnt(21)
    v_mfma_f32_32x32x16_bf16 a[128:143], v[10:13], a[100:103], a[128:143]
    v_exp_f32 v138, v138
    v_exp_f32 v139, v139
    v_cvt_pk_bf16_f32 v132, v136, v137
    s_waitcnt vmcnt(20)
    v_mfma_f32_32x32x16_bf16 a[128:143], v[10:13], a[104:107], a[128:143]
    buffer_load_dwordx4 a[16:19], v254, s[20:23], s101 offen offset:3584 sc1
    v_exp_f32 v140, v140
    s_add_u32 s101, s100, 26240
    v_exp_f32 v141, v141
    s_waitcnt vmcnt(20)
    v_mfma_f32_32x32x16_bf16 a[128:143], v[10:13], a[108:111], a[128:143]
    v_cvt_pk_bf16_f32 v133, v138, v139
    v_exp_f32 v142, v142
    v_exp_f32 v143, v143
    v_cvt_pk_bf16_f32 v134, v140, v141
    v_cvt_pk_bf16_f32 v135, v142, v143
    v_exp_f32 v144, v144
    v_mfma_f32_32x32x16_bf16 v[176:191], v[250:253], v[248:251], v[176:191]
    s_waitcnt lgkmcnt(4)
    buffer_load_dwordx4 a[20:23], v254, s[20:23], s101 offen offset:512 sc1
    v_exp_f32 v145, v145
    v_exp_f32 v146, v146
    v_cvt_pk_bf16_f32 v144, v144, v145
    v_mfma_f32_32x32x16_bf16 v[44:59], v[84:87], v[128:131], v[44:59]
    v_exp_f32 v147, v147
    v_exp_f32 v148, v148
    v_exp_f32 v149, v149
    v_mfma_f32_32x32x16_bf16 v[44:59], v[88:91], v[132:135], v[44:59]
    buffer_load_dwordx4 a[24:27], v254, s[20:23], s101 offen offset:1536 sc1
    ds_read_b64_tr_b16 v[84:85], v227 offset:11520
    ds_read_b64_tr_b16 v[86:87], v228 offset:11520
    v_cvt_pk_bf16_f32 v145, v146, v147
    v_exp_f32 v150, v150
    v_exp_f32 v151, v151
    v_cvt_pk_bf16_f32 v146, v148, v149
    v_exp_f32 v152, v152
    s_waitcnt vmcnt(21)
    v_mfma_f32_32x32x16_bf16 a[128:143], v[10:13], a[112:115], a[128:143]
    buffer_load_dwordx4 a[28:31], v254, s[20:23], s101 offen offset:2560 sc1
    ds_read_b64_tr_b16 v[88:89], v229 offset:11520
    ds_read_b64_tr_b16 v[90:91], v230 offset:11520
    v_exp_f32 v153, v153
    s_waitcnt vmcnt(21)
    v_mfma_f32_32x32x16_bf16 a[128:143], v[10:13], a[116:119], a[128:143]
    v_cvt_pk_bf16_f32 v147, v150, v151
    v_exp_f32 v154, v154
    v_exp_f32 v155, v155
    v_cvt_pk_bf16_f32 v148, v152, v153
    s_waitcnt vmcnt(20)
    v_mfma_f32_32x32x16_bf16 a[128:143], v[10:13], a[120:123], a[128:143]
    buffer_load_dwordx4 a[32:35], v254, s[20:23], s101 offen offset:3584 sc1
    v_exp_f32 v156, v156
    s_add_u32 s101, s100, 0
    v_exp_f32 v157, v157
    s_waitcnt vmcnt(20)
    v_mfma_f32_32x32x16_bf16 a[128:143], v[10:13], a[124:127], a[128:143]
    v_cvt_pk_bf16_f32 v149, v154, v155
    v_exp_f32 v158, v158
    v_exp_f32 v159, v159
    v_cvt_pk_bf16_f32 v150, v156, v157
    v_cvt_pk_bf16_f32 v151, v158, v159
    v_exp_f32 v160, v160
    v_mfma_f32_32x32x16_bf16 v[192:207], v[250:253], v[248:251], v[192:207]
    s_waitcnt lgkmcnt(4)
    buffer_load_dwordx4 a[36:39], v254, s[20:23], s101 offen offset:512 sc1
    v_exp_f32 v161, v161
    v_exp_f32 v162, v162
    v_exp_f32 v163, v163
    v_cvt_pk_bf16_f32 v160, v160, v161
    v_mfma_f32_32x32x16_bf16 v[44:59], v[76:79], v[144:147], v[44:59]
    v_exp_f32 v164, v164
    v_exp_f32 v165, v165
    v_cvt_pk_bf16_f32 v161, v162, v163
    v_exp_f32 v166, v166
    v_mfma_f32_32x32x16_bf16 v[44:59], v[80:83], v[148:151], v[44:59]
    buffer_load_dwordx4 a[40:43], v254, s[20:23], s101 offen offset:1536 sc1
    v_exp_f32 v167, v167
    v_cvt_pk_bf16_f32 v162, v164, v165
    v_exp_f32 v168, v168
    v_exp_f32 v169, v169
    v_cvt_pk_bf16_f32 v163, v166, v167
    v_exp_f32 v170, v170
    v_exp_f32 v171, v171
    v_cvt_pk_bf16_f32 v164, v168, v169
    v_exp_f32 v172, v172
    v_exp_f32 v173, v173
    v_cvt_pk_bf16_f32 v165, v170, v171
    v_exp_f32 v174, v174
    v_exp_f32 v175, v175
    v_cvt_pk_bf16_f32 v166, v172, v173
    v_cvt_pk_bf16_f32 v167, v174, v175
    v_accvgpr_read_b32 v10, a128
    v_accvgpr_read_b32 v11, a129
    v_accvgpr_read_b32 v12, a130
    v_accvgpr_read_b32 v13, a131
    v_accvgpr_read_b32 v18, a132
    v_accvgpr_read_b32 v19, a133
    v_accvgpr_read_b32 v20, a134
    ds_read_b64_tr_b16 v[76:77], v227 offset:14080
    ds_read_b64_tr_b16 v[78:79], v228 offset:14080
    buffer_load_dwordx4 a[44:47], v254, s[20:23], s101 offen offset:2560 sc1
    ds_read_b64_tr_b16 v[80:81], v229 offset:14080
    ds_read_b64_tr_b16 v[82:83], v230 offset:14080
    v_accvgpr_read_b32 v21, a135
    v_cvt_pk_bf16_f32 v10, v10, v11
    v_cvt_pk_bf16_f32 v11, v12, v13
    v_cvt_pk_bf16_f32 v12, v18, v19
    v_cvt_pk_bf16_f32 v13, v20, v21
    buffer_load_dwordx4 a[48:51], v254, s[20:23], s101 offen offset:3584 sc1
    s_add_u32 s101, s100, 20992
    ds_write_b128 v95, v[10:13]
    ds_read_b128 a[78:81], v237 offset:0
    ds_read_b128 a[82:85], v237 offset:5120
    ds_read_b32 a76, v232 offset:0
    ds_read_b128 a[102:105], v237 offset:1280
    ds_read_b128 a[106:109], v237 offset:6400
    ds_read_b32 a100, v232 offset:1280
    buffer_load_dwordx4 a[52:55], v254, s[20:23], s101 offen offset:512 sc1
    buffer_load_dwordx4 a[56:59], v254, s[20:23], s101 offen offset:1536 sc1
    buffer_load_dwordx4 a[60:63], v254, s[20:23], s101 offen offset:2560 sc1
    s_waitcnt lgkmcnt(0)
    s_barrier
    s_waitcnt vmcnt(15)
    v_cmp_ne_u64 vcc, s[58:59], v[244:245]
    s_cbranch_vccz .Lqf3
    s_mov_b32 s62, 393216
    s_mov_b32 s63, 300000
.Lpf3:
    buffer_load_dwordx2 v[244:245], v243, s[20:23], s62 offen sc1
    s_waitcnt vmcnt(0)
    v_cmp_ne_u64 vcc, s[58:59], v[244:245]
    s_sub_u32 s63, s63, 1
    s_cbranch_scc1 .Lend
    s_cbranch_vccnz .Lpf3
.Lqf3:
    ds_read_b128 a[64:67], v231 offset:0
    ds_read_b128 a[68:71], v231 offset:4096
    ds_read_b32 a136, v94 offset:0
    ds_read_b128 a[88:91], v231 offset:1024
    ds_read_b128 a[92:95], v231 offset:5120
    ds_read_b32 a140, v94 offset:1024
    v_exp_f32 v176, v176
    v_mfma_f32_32x32x16_bf16 v[208:223], v[250:253], v[248:251], v[208:223]
    v_exp_f32 v177, v177
    v_exp_f32 v178, v178
    v_exp_f32 v179, v179
    v_cvt_pk_bf16_f32 v176, v176, v177
    v_exp_f32 v180, v180
    v_mfma_f32_32x32x16_bf16 v[44:59], v[84:87], v[160:163], v[44:59]
    v_exp_f32 v181, v181
    v_cvt_pk_bf16_f32 v177, v178, v179
    v_exp_f32 v182, v182
    v_exp_f32 v183, v183
    v_cvt_pk_bf16_f32 v178, v180, v181
    v_mfma_f32_32x32x16_bf16 v[44:59], v[88:91], v[164:167], v[44:59]
    s_waitcnt lgkmcnt(3)
    v_exp_f32 v184, v184
    v_exp_f32 v185, v185
    v_mfma_f32_32x32x16_bf16 v[10:25], a[64:67], a[78:81], 0
    s_waitcnt lgkmcnt(2)
    v_cvt_pk_bf16_f32 v179, v182, v183
    v_exp_f32 v186, v186
    v_exp_f32 v187, v187
    v_mfma_f32_32x32x16_bf16 v[10:25], a[68:71], a[82:85], v[10:25]
    s_waitcnt lgkmcnt(1)
    v_cvt_pk_bf16_f32 v180, v184, v185
    v_exp_f32 v188, v188
    v_mfma_f32_32x32x16_bf16 v[10:25], a[136:139], a[76:79], v[10:25]
    s_waitcnt lgkmcnt(0)
    ds_read_b64_tr_b16 v[84:85], v227 offset:16640
    v_exp_f32 v189, v189
    v_mfma_f32_32x32x16_bf16 v[60:75], a[88:91], a[102:105], 0
    v_cvt_pk_bf16_f32 v181, v186, v187
    v_exp_f32 v190, v190
    v_mfma_f32_32x32x16_bf16 v[60:75], a[92:95], a[106:109], v[60:75]
    v_exp_f32 v191, v191
    v_cvt_pk_bf16_f32 v182, v188, v189
    v_mfma_f32_32x32x16_bf16 v[60:75], a[140:143], a[100:103], v[60:75]
    ds_read_b64_tr_b16 v[86:87], v228 offset:16640
    v_cvt_pk_bf16_f32 v183, v190, v191
    v_add_f32 v20, 0x358637bd, v20
    v_rcp_f32 v20, v20
    s_nop 0
    v_mul_f32 v20, v225, v20
    v_mul_f32 v10, v10, v20
    v_mul_f32 v11, v11, v20
    v_cvt_pk_bf16_f32 v22, v10, v11
    v_mul_f32 v12, v12, v20
    v_mul_f32 v13, v13, v20
    v_cvt_pk_bf16_f32 v23, v12, v13
    v_mul_f32 v14, v14, v20
    v_mul_f32 v15, v15, v20
    v_cvt_pk_bf16_f32 v24, v14, v15
    v_mul_f32 v16, v16, v20
    v_mul_f32 v17, v17, v20
    s_add_u32 s101, s100, 20992
    buffer_load_dwordx4 a[128:131], v254, s[20:23], s101 offen offset:3584 sc1
    ds_read_b64_tr_b16 v[88:89], v229 offset:16640
    ds_read_b64_tr_b16 v[90:91], v230 offset:16640
    v_cvt_pk_bf16_f32 v25, v16, v17
    v_mul_f32 v18, v18, v20
    v_mul_f32 v19, v19, v20
    v_cvt_pk_bf16_f32 v238, v18, v19
    v_add_f32 v70, 0x358637bd, v70
    v_mfma_f32_32x32x16_bf16 v[44:59], v[76:79], v[176:179], v[44:59]
    v_rcp_f32 v70, v70
    buffer_store_dwordx4 v[22:25], v240, s[20:23], s16 offen offset:2048 sc1
    v_mul_f32 v70, v225, v70
    v_mul_f32 v60, v60, v70
    v_mfma_f32_32x32x16_bf16 v[44:59], v[80:83], v[180:183], v[44:59]
    v_mul_f32 v61, v61, v70
    v_cvt_pk_bf16_f32 v72, v60, v61
    v_mul_f32 v62, v62, v70
    v_mul_f32 v63, v63, v70
    v_cvt_pk_bf16_f32 v73, v62, v63
    v_mul_f32 v64, v64, v70
    v_mul_f32 v65, v65, v70
    v_cvt_pk_bf16_f32 v74, v64, v65
    v_mul_f32 v66, v66, v70
    v_mul_f32 v67, v67, v70
    v_cvt_pk_bf16_f32 v75, v66, v67
    v_mul_f32 v68, v68, v70
    v_mul_f32 v69, v69, v70
    v_cvt_pk_bf16_f32 v239, v68, v69
    v_exp_f32 v192, v192
    v_exp_f32 v193, v193
    v_exp_f32 v194, v194
    v_exp_f32 v195, v195
    v_cvt_pk_bf16_f32 v192, v192, v193
    buffer_store_dwordx4 v[72:75], v240, s[20:23], s4 offen offset:0 sc1
    ds_read_b64_tr_b16 v[76:77], v227 offset:19200
    ds_read_b64_tr_b16 v[78:79], v228 offset:19200
    ds_read_b64_tr_b16 v[80:81], v229 offset:19200
    ds_read_b64_tr_b16 v[82:83], v230 offset:19200
    v_exp_f32 v196, v196
    v_exp_f32 v197, v197
    v_cvt_pk_bf16_f32 v193, v194, v195
    buffer_load_dwordx4 v[96:99], v224, s[20:23], s7 offen offset:0 sc1
    v_exp_f32 v198, v198
    v_exp_f32 v199, v199
    v_cvt_pk_bf16_f32 v194, v196, v197
    v_exp_f32 v200, v200
    v_exp_f32 v201, v201
    v_cvt_pk_bf16_f32 v195, v198, v199
    v_exp_f32 v202, v202
    buffer_load_dwordx4 v[100:103], v224, s[20:23], s8 offen offset:0 sc1
    v_exp_f32 v203, v203
    v_cvt_pk_bf16_f32 v196, v200, v201
    v_exp_f32 v204, v204
    v_exp_f32 v205, v205
    v_cvt_pk_bf16_f32 v197, v202, v203
    v_exp_f32 v206, v206
    v_exp_f32 v207, v207
    buffer_load_dwordx4 v[104:107], v224, s[20:23], s9 offen offset:0 sc1
    v_cvt_pk_bf16_f32 v198, v204, v205
    v_cvt_pk_bf16_f32 v199, v206, v207
    v_exp_f32 v208, v208
    s_waitcnt lgkmcnt(6)
    v_mfma_f32_32x32x16_bf16 v[44:59], v[84:87], v[192:195], v[44:59]
    v_exp_f32 v209, v209
    v_exp_f32 v210, v210
    buffer_load_dwordx4 v[108:111], v224, s[20:23], s10 offen offset:0 sc1
    v_exp_f32 v211, v211
    v_cvt_pk_bf16_f32 v208, v208, v209
    v_exp_f32 v212, v212
    v_exp_f32 v213, v213
    v_cvt_pk_bf16_f32 v209, v210, v211
    v_exp_f32 v214, v214
    buffer_load_dwordx4 v[112:115], v224, s[20:23], s7 offen offset:1024 sc1
    v_exp_f32 v215, v215
    v_cvt_pk_bf16_f32 v210, v212, v213
    v_exp_f32 v216, v216
    v_exp_f32 v217, v217
    s_waitcnt lgkmcnt(4)
    v_mfma_f32_32x32x16_bf16 v[44:59], v[88:91], v[196:199], v[44:59]
    v_cvt_pk_bf16_f32 v211, v214, v215
    buffer_load_dwordx4 v[116:119], v224, s[20:23], s8 offen offset:1024 sc1
    v_exp_f32 v218, v218
    v_exp_f32 v219, v219
    v_cvt_pk_bf16_f32 v212, v216, v217
    v_exp_f32 v220, v220
    v_exp_f32 v221, v221
    v_cvt_pk_bf16_f32 v213, v218, v219
    buffer_load_dwordx4 v[120:123], v224, s[20:23], s9 offen offset:1024 sc1
    v_exp_f32 v222, v222
    v_exp_f32 v223, v223
    v_cvt_pk_bf16_f32 v214, v220, v221
    v_cvt_pk_bf16_f32 v215, v222, v223
    s_waitcnt lgkmcnt(2)
    v_mfma_f32_32x32x16_bf16 v[44:59], v[76:79], v[208:211], v[44:59]
    s_waitcnt lgkmcnt(0)
    buffer_load_dwordx4 v[124:127], v224, s[20:23], s10 offen offset:1024 sc1
    v_mfma_f32_32x32x16_bf16 v[44:59], v[80:83], v[212:215], v[44:59]
    s_nop 7
    s_nop 3
    v_rcp_f32 v54, v54
    s_nop 0
    v_mul_f32 v54, v226, v54
    v_pk_mul_f32 v[44:45], v[44:45], v[54:55] op_sel_hi:[1,0]
    v_cvt_pk_bf16_f32 v56, v44, v45
    v_pk_mul_f32 v[46:47], v[46:47], v[54:55] op_sel_hi:[1,0]
    v_cvt_pk_bf16_f32 v57, v46, v47
    v_pk_mul_f32 v[48:49], v[48:49], v[54:55] op_sel_hi:[1,0]
    v_cvt_pk_bf16_f32 v58, v48, v49
    v_pk_mul_f32 v[50:51], v[50:51], v[54:55] op_sel_hi:[1,0]
    v_cvt_pk_bf16_f32 v59, v50, v51
    buffer_store_dwordx4 v[56:59], v240, s[20:23], s4 offen offset:2048 sc1
    v_pk_mul_f32 v[52:53], v[52:53], v[54:55] op_sel_hi:[1,0]
    v_cvt_pk_bf16_f32 v237, v52, v53
    s_mov_b32 exec_hi, 0
    buffer_store_dwordx4 v[236:239], v241, s[20:23], s17 offen sc1
    s_mov_b32 exec_hi, -1
    s_mov_b32 s69, 300000
    buffer_load_dwordx4 v[128:131], v224, s[20:23], s7 offen offset:2048 sc1
    buffer_load_dwordx4 v[132:135], v224, s[20:23], s8 offen offset:2048 sc1
    s_waitcnt vmcnt(9)
    v_max3_u32 v94, v96, v100, v104
    s_waitcnt vmcnt(8)
    v_max_u32 v94, v94, v108
    v_cmp_eq_u32 vcc, -1, v94
    s_cbranch_vccnz .Lra0
.Lba0:
    v_mfma_f32_16x16x32_bf16 v[144:147], a[196:199], v[96:99], 0
    buffer_load_dwordx4 v[136:139], v224, s[20:23], s9 offen offset:2048 sc1
    v_mfma_f32_16x16x32_bf16 v[148:151], a[200:203], v[96:99], 0
    v_add_u32 v28, 4096, v224
    v_mfma_f32_16x16x32_bf16 v[152:155], a[204:207], v[96:99], 0
    v_add_u32 v29, 8192, v224
    v_mfma_f32_16x16x32_bf16 v[156:159], a[208:211], v[96:99], 0
    v_lshl_add_u32 v35, s28, 14, v224
    buffer_load_dwordx4 v[140:143], v224, s[20:23], s10 offen offset:2048 sc1
    v_mfma_f32_16x16x32_bf16 v[160:163], a[164:167], v[96:99], 0
    v_xor_b32 v30, 16384, v35
    v_mfma_f32_16x16x32_bf16 v[164:167], a[196:199], v[100:103], 0
    v_xor_b32 v31, 32768, v35
    v_mfma_f32_16x16x32_bf16 v[168:171], a[200:203], v[100:103], 0
    v_xor_b32 v32, 49152, v35
    v_mfma_f32_16x16x32_bf16 v[172:175], a[204:207], v[100:103], 0
    v_and_b32 v33, 15, v0
    buffer_load_dwordx4 v[60:63], v224, s[20:23], s7 offen offset:3072 sc1
    v_mfma_f32_16x16x32_bf16 v[176:179], a[208:211], v[100:103], 0
    v_mul_u32_u24 v33, 1152, v33
    v_mfma_f32_16x16x32_bf16 v[180:183], a[164:167], v[100:103], 0
    v_bfe_u32 v34, v0, 4, 1
    v_mfma_f32_16x16x32_bf16 v[184:187], a[196:199], v[104:107], 0
    v_lshl_add_u32 v34, v34, 3, v33
    buffer_load_dwordx4 v[64:67], v224, s[20:23], s8 offen offset:3072 sc1
    v_mfma_f32_16x16x32_bf16 v[188:191], a[200:203], v[104:107], 0
    v_and_b32 v36, 48, v0
    v_mfma_f32_16x16x32_bf16 v[192:195], a[204:207], v[104:107], 0
    v_add_u32 v33, v36, v33
    v_mfma_f32_16x16x32_bf16 v[196:199], a[208:211], v[104:107], 0
    s_lshl2_add_u32 s62, s97, s28
    v_mfma_f32_16x16x32_bf16 v[200:203], a[164:167], v[104:107], 0
    s_mul_i32 s62, s62, 18432
    buffer_load_dwordx4 v[68:71], v224, s[20:23], s9 offen offset:3072 sc1
    v_mfma_f32_16x16x32_bf16 v[204:207], a[196:199], v[108:111], 0
    s_mul_i32 s63, s96, 144
    v_mfma_f32_16x16x32_bf16 v[208:211], a[200:203], v[108:111], 0
    s_add_u32 s68, s62, s63
    v_mfma_f32_16x16x32_bf16 v[212:215], a[204:207], v[108:111], 0
    s_mov_b32 s24, s48
    buffer_load_dwordx4 v[72:75], v224, s[20:23], s10 offen offset:3072 sc1
    s_waitcnt vmcnt(11)
    v_max3_u32 v94, v112, v116, v120
    v_mfma_f32_16x16x32_bf16 v[216:219], a[208:211], v[108:111], 0
    s_mov_b32 s25, s49
    s_waitcnt vmcnt(10)
    v_max_u32 v94, v94, v124
    v_cmp_eq_u32 vcc, -1, v94
    v_mfma_f32_16x16x32_bf16 v[220:223], a[164:167], v[108:111], 0
    s_mov_b32 s26, 2359296
    s_cbranch_vccnz .Lra1
.Lba1:
    v_mfma_f32_16x16x32_bf16 v[144:147], a[212:215], v[112:115], v[144:147]
    s_mov_b32 s27, 0x20000
    v_mfma_f32_16x16x32_bf16 v[148:151], a[216:219], v[112:115], v[148:151]
    buffer_load_dwordx4 v[76:79], v28, s[20:23], s7 offen offset:0 sc1
    v_mfma_f32_16x16x32_bf16 v[152:155], a[220:223], v[112:115], v[152:155]
    v_mfma_f32_16x16x32_bf16 v[156:159], a[224:227], v[112:115], v[156:159]
    v_mfma_f32_16x16x32_bf16 v[160:163], a[168:171], v[112:115], v[160:163]
    buffer_load_dwordx4 v[80:83], v28, s[20:23], s8 offen offset:0 sc1
    v_mfma_f32_16x16x32_bf16 v[164:167], a[212:215], v[116:119], v[164:167]
    v_mfma_f32_16x16x32_bf16 v[168:171], a[216:219], v[116:119], v[168:171]
    v_mfma_f32_16x16x32_bf16 v[172:175], a[220:223], v[116:119], v[172:175]
    v_mfma_f32_16x16x32_bf16 v[176:179], a[224:227], v[116:119], v[176:179]
    buffer_load_dwordx4 v[84:87], v28, s[20:23], s9 offen offset:0 sc1
    v_mfma_f32_16x16x32_bf16 v[180:183], a[168:171], v[116:119], v[180:183]
    v_mfma_f32_16x16x32_bf16 v[184:187], a[212:215], v[120:123], v[184:187]
    v_mfma_f32_16x16x32_bf16 v[188:191], a[216:219], v[120:123], v[188:191]
    buffer_load_dwordx4 v[88:91], v28, s[20:23], s10 offen offset:0 sc1
    v_mfma_f32_16x16x32_bf16 v[192:195], a[220:223], v[120:123], v[192:195]
    v_mfma_f32_16x16x32_bf16 v[196:199], a[224:227], v[120:123], v[196:199]
    v_mfma_f32_16x16x32_bf16 v[200:203], a[168:171], v[120:123], v[200:203]
    v_mfma_f32_16x16x32_bf16 v[204:207], a[212:215], v[124:127], v[204:207]
    buffer_load_dwordx4 v[10:13], v28, s[20:23], s7 offen offset:1024 sc1
    v_mfma_f32_16x16x32_bf16 v[208:211], a[216:219], v[124:127], v[208:211]
    v_mfma_f32_16x16x32_bf16 v[212:215], a[220:223], v[124:127], v[212:215]
    s_waitcnt vmcnt(10)
    v_max3_u32 v94, v128, v132, v136
    v_mfma_f32_16x16x32_bf16 v[216:219], a[224:227], v[124:127], v[216:219]
    buffer_load_dwordx4 v[14:17], v28, s[20:23], s8 offen offset:1024 sc1
    s_waitcnt vmcnt(10)
    v_max_u32 v94, v94, v140
    v_cmp_eq_u32 vcc, -1, v94
    v_mfma_f32_16x16x32_bf16 v[220:223], a[168:171], v[124:127], v[220:223]
    s_cbranch_vccnz .Lra2
.Lba2:
    v_mfma_f32_16x16x32_bf16 v[144:147], a[228:231], v[128:131], v[144:147]
    v_mfma_f32_16x16x32_bf16 v[148:151], a[232:235], v[128:131], v[148:151]
    v_mfma_f32_16x16x32_bf16 v[152:155], a[236:239], v[128:131], v[152:155]
    buffer_load_dwordx4 v[18:21], v28, s[20:23], s9 offen offset:1024 sc1
    v_mfma_f32_16x16x32_bf16 v[156:159], a[240:243], v[128:131], v[156:159]
    v_mfma_f32_16x16x32_bf16 v[160:163], a[172:175], v[128:131], v[160:163]
    v_mfma_f32_16x16x32_bf16 v[164:167], a[228:231], v[132:135], v[164:167]
    buffer_load_dwordx4 v[22:25], v28, s[20:23], s10 offen offset:1024 sc1
    v_mfma_f32_16x16x32_bf16 v[168:171], a[232:235], v[132:135], v[168:171]
    v_mfma_f32_16x16x32_bf16 v[172:175], a[236:239], v[132:135], v[172:175]
    v_mfma_f32_16x16x32_bf16 v[176:179], a[240:243], v[132:135], v[176:179]
    v_mfma_f32_16x16x32_bf16 v[180:183], a[172:175], v[132:135], v[180:183]
    v_mfma_f32_16x16x32_bf16 v[184:187], a[228:231], v[136:139], v[184:187]
    v_mfma_f32_16x16x32_bf16 v[188:191], a[232:235], v[136:139], v[188:191]
    v_mfma_f32_16x16x32_bf16 v[192:195], a[236:239], v[136:139], v[192:195]
    v_mfma_f32_16x16x32_bf16 v[196:199], a[240:243], v[136:139], v[196:199]
    v_mfma_f32_16x16x32_bf16 v[200:203], a[172:175], v[136:139], v[200:203]
    v_mfma_f32_16x16x32_bf16 v[204:207], a[228:231], v[140:143], v[204:207]
    v_mfma_f32_16x16x32_bf16 v[208:211], a[232:235], v[140:143], v[208:211]
    v_mfma_f32_16x16x32_bf16 v[212:215], a[236:239], v[140:143], v[212:215]
    s_waitcnt vmcnt(9)
    v_max3_u32 v94, v60, v64, v68
    v_mfma_f32_16x16x32_bf16 v[216:219], a[240:243], v[140:143], v[216:219]
    s_waitcnt vmcnt(8)
    v_max_u32 v94, v94, v72
    v_cmp_eq_u32 vcc, -1, v94
    v_mfma_f32_16x16x32_bf16 v[220:223], a[172:175], v[140:143], v[220:223]
    s_cbranch_vccnz .Lra3
.Lba3:
    v_mfma_f32_16x16x32_bf16 v[144:147], a[244:247], v[60:63], v[144:147]
    v_mfma_f32_16x16x32_bf16 v[148:151], a[248:251], v[60:63], v[148:151]
    v_mfma_f32_16x16x32_bf16 v[152:155], a[252:255], v[60:63], v[152:155]
    v_mfma_f32_16x16x32_bf16 v[156:159], a[0:3], v[60:63], v[156:159]
    v_mfma_f32_16x16x32_bf16 v[160:163], a[176:179], v[60:63], v[160:163]
    v_mfma_f32_16x16x32_bf16 v[164:167], a[244:247], v[64:67], v[164:167]
    v_mfma_f32_16x16x32_bf16 v[168:171], a[248:251], v[64:67], v[168:171]
    v_mfma_f32_16x16x32_bf16 v[172:175], a[252:255], v[64:67], v[172:175]
    v_mfma_f32_16x16x32_bf16 v[176:179], a[0:3], v[64:67], v[176:179]
    buffer_load_dwordx4 v[100:103], v28, s[20:23], s8 offen offset:2048 sc1
    v_mfma_f32_16x16x32_bf16 v[180:183], a[176:179], v[64:67], v[180:183]
    v_mfma_f32_16x16x32_bf16 v[184:187], a[244:247], v[68:71], v[184:187]
    v_mfma_f32_16x16x32_bf16 v[188:191], a[248:251], v[68:71], v[188:191]
    buffer_load_dwordx4 v[116:119], v28, s[20:23], s8 offen offset:3072 sc1
    v_mfma_f32_16x16x32_bf16 v[192:195], a[252:255], v[68:71], v[192:195]
    v_mfma_f32_16x16x32_bf16 v[196:199], a[0:3], v[68:71], v[196:199]
    v_mfma_f32_16x16x32_bf16 v[200:203], a[176:179], v[68:71], v[200:203]
    buffer_load_dwordx4 v[132:135], v29, s[20:23], s8 offen offset:0 sc1
    v_mfma_f32_16x16x32_bf16 v[204:207], a[244:247], v[72:75], v[204:207]
    v_mfma_f32_16x16x32_bf16 v[208:211], a[248:251], v[72:75], v[208:211]
    v_mfma_f32_16x16x32_bf16 v[212:215], a[252:255], v[72:75], v[212:215]
    buffer_load_dwordx4 v[104:107], v28, s[20:23], s9 offen offset:2048 sc1
    s_waitcnt vmcnt(9)
    v_max3_u32 v94, v76, v80, v84
    v_mfma_f32_16x16x32_bf16 v[216:219], a[0:3], v[72:75], v[216:219]
    s_waitcnt vmcnt(8)
    v_max_u32 v94, v94, v88
    v_cmp_eq_u32 vcc, -1, v94
    v_mfma_f32_16x16x32_bf16 v[220:223], a[176:179], v[72:75], v[220:223]
    s_cbranch_vccnz .Lra4
.Lba4:
    v_mfma_f32_16x16x32_bf16 v[144:147], a[4:7], v[76:79], v[144:147]
    buffer_load_dwordx4 v[120:123], v28, s[20:23], s9 offen offset:3072 sc1
    v_mfma_f32_16x16x32_bf16 v[148:151], a[8:11], v[76:79], v[148:151]
    v_mfma_f32_16x16x32_bf16 v[152:155], a[12:15], v[76:79], v[152:155]
    v_mfma_f32_16x16x32_bf16 v[156:159], a[16:19], v[76:79], v[156:159]
    buffer_load_dwordx4 v[136:139], v29, s[20:23], s9 offen offset:0 sc1
    v_mfma_f32_16x16x32_bf16 v[160:163], a[180:183], v[76:79], v[160:163]
    v_mfma_f32_16x16x32_bf16 v[164:167], a[4:7], v[80:83], v[164:167]
    v_mfma_f32_16x16x32_bf16 v[168:171], a[8:11], v[80:83], v[168:171]
    buffer_load_dwordx4 v[108:111], v28, s[20:23], s10 offen offset:2048 sc1
    v_mfma_f32_16x16x32_bf16 v[172:175], a[12:15], v[80:83], v[172:175]
    v_mfma_f32_16x16x32_bf16 v[176:179], a[16:19], v[80:83], v[176:179]
    v_mfma_f32_16x16x32_bf16 v[180:183], a[180:183], v[80:83], v[180:183]
    buffer_load_dwordx4 v[124:127], v28, s[20:23], s10 offen offset:3072 sc1
    v_mfma_f32_16x16x32_bf16 v[184:187], a[4:7], v[84:87], v[184:187]
    v_mfma_f32_16x16x32_bf16 v[188:191], a[8:11], v[84:87], v[188:191]
    v_mfma_f32_16x16x32_bf16 v[192:195], a[12:15], v[84:87], v[192:195]
    buffer_load_dwordx4 v[140:143], v29, s[20:23], s10 offen offset:0 sc1
    v_mfma_f32_16x16x32_bf16 v[196:199], a[16:19], v[84:87], v[196:199]
    v_mfma_f32_16x16x32_bf16 v[200:203], a[180:183], v[84:87], v[200:203]
    v_mfma_f32_16x16x32_bf16 v[204:207], a[4:7], v[88:91], v[204:207]
    buffer_load_dwordx4 v[96:99], v28, s[20:23], s7 offen offset:2048 sc1
    v_mfma_f32_16x16x32_bf16 v[208:211], a[8:11], v[88:91], v[208:211]
    v_mfma_f32_16x16x32_bf16 v[212:215], a[12:15], v[88:91], v[212:215]
    s_waitcnt vmcnt(11)
    v_max3_u32 v94, v10, v14, v18
    v_mfma_f32_16x16x32_bf16 v[216:219], a[16:19], v[88:91], v[216:219]
    buffer_load_dwordx4 v[112:115], v28, s[20:23], s7 offen offset:3072 sc1
    s_waitcnt vmcnt(11)
    v_max_u32 v94, v94, v22
    v_cmp_eq_u32 vcc, -1, v94
    v_mfma_f32_16x16x32_bf16 v[220:223], a[180:183], v[88:91], v[220:223]
    s_cbranch_vccnz .Lra5
.Lba5:
    v_mfma_f32_16x16x32_bf16 v[144:147], a[20:23], v[10:13], v[144:147]
    v_mfma_f32_16x16x32_bf16 v[148:151], a[24:27], v[10:13], v[148:151]
    buffer_load_dwordx4 v[128:131], v29, s[20:23], s7 offen offset:0 sc1
    v_mfma_f32_16x16x32_bf16 v[152:155], a[28:31], v[10:13], v[152:155]
    v_mfma_f32_16x16x32_bf16 v[156:159], a[32:35], v[10:13], v[156:159]
    v_mfma_f32_16x16x32_bf16 v[160:163], a[184:187], v[10:13], v[160:163]
    v_mfma_f32_16x16x32_bf16 v[164:167], a[20:23], v[14:17], v[164:167]
    v_mfma_f32_16x16x32_bf16 v[168:171], a[24:27], v[14:17], v[168:171]
    v_mfma_f32_16x16x32_bf16 v[172:175], a[28:31], v[14:17], v[172:175]
    v_mfma_f32_16x16x32_bf16 v[176:179], a[32:35], v[14:17], v[176:179]
    v_mfma_f32_16x16x32_bf16 v[180:183], a[184:187], v[14:17], v[180:183]
    v_mfma_f32_16x16x32_bf16 v[184:187], a[20:23], v[18:21], v[184:187]
    v_mfma_f32_16x16x32_bf16 v[188:191], a[24:27], v[18:21], v[188:191]
    v_mfma_f32_16x16x32_bf16 v[192:195], a[28:31], v[18:21], v[192:195]
    v_mfma_f32_16x16x32_bf16 v[196:199], a[32:35], v[18:21], v[196:199]
    v_mfma_f32_16x16x32_bf16 v[200:203], a[184:187], v[18:21], v[200:203]
    v_mfma_f32_16x16x32_bf16 v[204:207], a[20:23], v[22:25], v[204:207]
    v_mfma_f32_16x16x32_bf16 v[208:211], a[24:27], v[22:25], v[208:211]
    v_mfma_f32_16x16x32_bf16 v[212:215], a[28:31], v[22:25], v[212:215]
    s_waitcnt vmcnt(9)
    v_max3_u32 v94, v100, v116, v132
    v_mfma_f32_16x16x32_bf16 v[216:219], a[32:35], v[22:25], v[216:219]
    v_cmp_eq_u32 vcc, -1, v94
    v_mfma_f32_16x16x32_bf16 v[220:223], a[184:187], v[22:25], v[220:223]
    s_cbranch_vccnz .Lrb0
.Lbb0:
    v_mfma_f32_16x16x32_bf16 v[164:167], a[36:39], v[100:103], v[164:167]
    v_mfma_f32_16x16x32_bf16 v[168:171], a[40:43], v[100:103], v[168:171]
    v_mfma_f32_16x16x32_bf16 v[172:175], a[44:47], v[100:103], v[172:175]
    v_mfma_f32_16x16x32_bf16 v[176:179], a[48:51], v[100:103], v[176:179]
    v_mfma_f32_16x16x32_bf16 v[180:183], a[188:191], v[100:103], v[180:183]
    v_mfma_f32_16x16x32_bf16 v[164:167], a[52:55], v[116:119], v[164:167]
    v_mfma_f32_16x16x32_bf16 v[168:171], a[56:59], v[116:119], v[168:171]
    v_mfma_f32_16x16x32_bf16 v[172:175], a[60:63], v[116:119], v[172:175]
    v_mfma_f32_16x16x32_bf16 v[176:179], a[128:131], v[116:119], v[176:179]
    v_mfma_f32_16x16x32_bf16 v[180:183], a[192:195], v[116:119], v[180:183]
    v_mfma_f32_16x16x32_bf16 v[164:167], a[144:147], v[132:135], v[164:167]
    v_mfma_f32_16x16x32_bf16 v[168:171], a[148:151], v[132:135], v[168:171]
    v_mfma_f32_16x16x32_bf16 v[172:175], a[152:155], v[132:135], v[172:175]
    s_waitcnt vmcnt(6)
    v_max3_u32 v94, v104, v120, v136
    v_mfma_f32_16x16x32_bf16 v[176:179], a[156:159], v[132:135], v[176:179]
    v_cmp_eq_u32 vcc, -1, v94
    v_mfma_f32_16x16x32_bf16 v[180:183], a[160:163], v[132:135], v[180:183]
    s_cbranch_vccnz .Lrb1
.Lbb1:
    v_mfma_f32_16x16x32_bf16 v[184:187], a[36:39], v[104:107], v[184:187]
    v_mfma_f32_16x16x32_bf16 v[188:191], a[40:43], v[104:107], v[188:191]
    v_mfma_f32_16x16x32_bf16 v[192:195], a[44:47], v[104:107], v[192:195]
    ds_write_b128 v30, v[164:167] offset:0
    v_mfma_f32_16x16x32_bf16 v[196:199], a[48:51], v[104:107], v[196:199]
    v_mfma_f32_16x16x32_bf16 v[200:203], a[188:191], v[104:107], v[200:203]
    ds_write_b128 v30, v[168:171] offset:1024
    v_mfma_f32_16x16x32_bf16 v[184:187], a[52:55], v[120:123], v[184:187]
    v_mfma_f32_16x16x32_bf16 v[188:191], a[56:59], v[120:123], v[188:191]
    ds_write_b128 v30, v[172:175] offset:2048
    v_mfma_f32_16x16x32_bf16 v[192:195], a[60:63], v[120:123], v[192:195]
    v_mfma_f32_16x16x32_bf16 v[196:199], a[128:131], v[120:123], v[196:199]
    ds_write_b128 v30, v[176:179] offset:3072
    v_mfma_f32_16x16x32_bf16 v[200:203], a[192:195], v[120:123], v[200:203]
    v_mfma_f32_16x16x32_bf16 v[184:187], a[144:147], v[136:139], v[184:187]
    ds_write_b128 v30, v[180:183] offset:4096
    v_mfma_f32_16x16x32_bf16 v[188:191], a[148:151], v[136:139], v[188:191]
    v_mfma_f32_16x16x32_bf16 v[192:195], a[152:155], v[136:139], v[192:195]
    s_waitcnt vmcnt(3)
    v_max3_u32 v94, v108, v124, v140
    v_mfma_f32_16x16x32_bf16 v[196:199], a[156:159], v[136:139], v[196:199]
    v_cmp_eq_u32 vcc, -1, v94
    v_mfma_f32_16x16x32_bf16 v[200:203], a[160:163], v[136:139], v[200:203]
    s_cbranch_vccnz .Lrb2
.Lbb2:
    v_mfma_f32_16x16x32_bf16 v[204:207], a[36:39], v[108:111], v[204:207]
    v_mfma_f32_16x16x32_bf16 v[208:211], a[40:43], v[108:111], v[208:211]
    v_mfma_f32_16x16x32_bf16 v[212:215], a[44:47], v[108:111], v[212:215]
    ds_write_b128 v31, v[184:187] offset:5120
    v_mfma_f32_16x16x32_bf16 v[216:219], a[48:51], v[108:111], v[216:219]
    v_mfma_f32_16x16x32_bf16 v[220:223], a[188:191], v[108:111], v[220:223]
    ds_write_b128 v31, v[188:191] offset:6144
    v_mfma_f32_16x16x32_bf16 v[204:207], a[52:55], v[124:127], v[204:207]
    v_mfma_f32_16x16x32_bf16 v[208:211], a[56:59], v[124:127], v[208:211]
    ds_write_b128 v31, v[192:195] offset:7168
    v_mfma_f32_16x16x32_bf16 v[212:215], a[60:63], v[124:127], v[212:215]
    v_mfma_f32_16x16x32_bf16 v[216:219], a[128:131], v[124:127], v[216:219]
    ds_write_b128 v31, v[196:199] offset:8192
    v_mfma_f32_16x16x32_bf16 v[220:223], a[192:195], v[124:127], v[220:223]
    v_mfma_f32_16x16x32_bf16 v[204:207], a[144:147], v[140:143], v[204:207]
    ds_write_b128 v31, v[200:203] offset:9216
    v_mfma_f32_16x16x32_bf16 v[208:211], a[148:151], v[140:143], v[208:211]
    v_mfma_f32_16x16x32_bf16 v[212:215], a[152:155], v[140:143], v[212:215]
    s_waitcnt vmcnt(0)
    v_max3_u32 v94, v96, v112, v128
    v_mfma_f32_16x16x32_bf16 v[216:219], a[156:159], v[140:143], v[216:219]
    v_cmp_eq_u32 vcc, -1, v94
    v_mfma_f32_16x16x32_bf16 v[220:223], a[160:163], v[140:143], v[220:223]
    s_cbranch_vccnz .Lrb3
.Lbb3:
    ds_write_b128 v32, v[204:207] offset:10240
    v_mfma_f32_16x16x32_bf16 v[144:147], a[36:39], v[96:99], v[144:147]
    ds_write_b128 v32, v[208:211] offset:11264
    v_mfma_f32_16x16x32_bf16 v[148:151], a[40:43], v[96:99], v[148:151]
    ds_write_b128 v32, v[212:215] offset:12288
    v_mfma_f32_16x16x32_bf16 v[152:155], a[44:47], v[96:99], v[152:155]
    ds_write_b128 v32, v[216:219] offset:13312
    v_mfma_f32_16x16x32_bf16 v[156:159], a[48:51], v[96:99], v[156:159]
    ds_write_b128 v32, v[220:223] offset:14336
    v_mfma_f32_16x16x32_bf16 v[160:163], a[188:191], v[96:99], v[160:163]
    v_mfma_f32_16x16x32_bf16 v[144:147], a[52:55], v[112:115], v[144:147]
    v_mfma_f32_16x16x32_bf16 v[148:151], a[56:59], v[112:115], v[148:151]
    v_mfma_f32_16x16x32_bf16 v[152:155], a[60:63], v[112:115], v[152:155]
    s_waitcnt lgkmcnt(0)
    s_barrier
    ds_read_b128 v[164:167], v35 offset:0
    v_mfma_f32_16x16x32_bf16 v[156:159], a[128:131], v[112:115], v[156:159]
    ds_read_b128 v[168:171], v35 offset:5120
    ds_read_b128 v[172:175], v35 offset:10240
    v_mfma_f32_16x16x32_bf16 v[160:163], a[192:195], v[112:115], v[160:163]
    ds_read_b128 v[176:179], v35 offset:1024
    ds_read_b128 v[180:183], v35 offset:6144
    v_mfma_f32_16x16x32_bf16 v[144:147], a[144:147], v[128:131], v[144:147]
    ds_read_b128 v[184:187], v35 offset:11264
    ds_read_b128 v[188:191], v35 offset:2048
    v_mfma_f32_16x16x32_bf16 v[148:151], a[148:151], v[128:131], v[148:151]
    ds_read_b128 v[192:195], v35 offset:7168
    ds_read_b128 v[196:199], v35 offset:12288
    v_mfma_f32_16x16x32_bf16 v[152:155], a[152:155], v[128:131], v[152:155]
    ds_read_b128 v[200:203], v35 offset:3072
    ds_read_b128 v[204:207], v35 offset:8192
    v_mfma_f32_16x16x32_bf16 v[156:159], a[156:159], v[128:131], v[156:159]
    s_waitcnt lgkmcnt(10)
    ds_read_b128 v[208:211], v35 offset:13312
    ds_read_b128 v[212:215], v35 offset:4096
    v_mfma_f32_16x16x32_bf16 v[160:163], a[160:163], v[128:131], v[160:163]
    s_waitcnt lgkmcnt(9)
    ds_read_b128 v[216:219], v35 offset:9216
    ds_read_b128 v[220:223], v35 offset:14336
    v_pk_add_f32 v[164:165], v[164:165], v[168:169]
    v_pk_add_f32 v[144:145], v[144:145], v[172:173]
    v_pk_add_f32 v[166:167], v[166:167], v[170:171]
    v_pk_add_f32 v[146:147], v[146:147], v[174:175]
    v_pk_add_f32 v[144:145], v[144:145], v[164:165]
    v_pk_add_f32 v[146:147], v[146:147], v[166:167]
    v_cvt_pk_bf16_f32 v40, v144, v145
    v_cvt_pk_bf16_f32 v41, v146, v147
    s_waitcnt lgkmcnt(10)
    v_pk_add_f32 v[176:177], v[176:177], v[180:181]
    s_waitcnt lgkmcnt(9)
    v_pk_add_f32 v[148:149], v[148:149], v[184:185]
    v_pk_add_f32 v[178:179], v[178:179], v[182:183]
    v_pk_add_f32 v[150:151], v[150:151], v[186:187]
    v_pk_add_f32 v[148:149], v[148:149], v[176:177]
    v_pk_add_f32 v[150:151], v[150:151], v[178:179]
    v_cvt_pk_bf16_f32 v42, v148, v149
    v_cvt_pk_bf16_f32 v43, v150, v151
    buffer_store_dwordx4 v[40:43], v33, s[24:27], s68 offen offset:0
    s_waitcnt lgkmcnt(7)
    v_pk_add_f32 v[188:189], v[188:189], v[192:193]
    s_waitcnt lgkmcnt(6)
    v_pk_add_f32 v[152:153], v[152:153], v[196:197]
    v_pk_add_f32 v[190:191], v[190:191], v[194:195]
    v_pk_add_f32 v[154:155], v[154:155], v[198:199]
    v_pk_add_f32 v[152:153], v[152:153], v[188:189]
    v_pk_add_f32 v[154:155], v[154:155], v[190:191]
    v_cvt_pk_bf16_f32 v44, v152, v153
    v_cvt_pk_bf16_f32 v45, v154, v155
    s_waitcnt lgkmcnt(4)
    v_pk_add_f32 v[200:201], v[200:201], v[204:205]
    s_waitcnt lgkmcnt(3)
    v_pk_add_f32 v[156:157], v[156:157], v[208:209]
    v_pk_add_f32 v[202:203], v[202:203], v[206:207]
    v_pk_add_f32 v[158:159], v[158:159], v[210:211]
    v_pk_add_f32 v[156:157], v[156:157], v[200:201]
    v_pk_add_f32 v[158:159], v[158:159], v[202:203]
    v_cvt_pk_bf16_f32 v46, v156, v157
    v_cvt_pk_bf16_f32 v47, v158, v159
    buffer_store_dwordx4 v[44:47], v33, s[24:27], s68 offen offset:64
    s_waitcnt lgkmcnt(1)
    v_pk_add_f32 v[212:213], v[212:213], v[216:217]
    s_waitcnt lgkmcnt(0)
    v_pk_add_f32 v[160:161], v[160:161], v[220:221]
    v_pk_add_f32 v[214:215], v[214:215], v[218:219]
    v_pk_add_f32 v[162:163], v[162:163], v[222:223]
    v_pk_add_f32 v[160:161], v[160:161], v[212:213]
    v_pk_add_f32 v[162:163], v[162:163], v[214:215]
    v_cvt_pk_bf16_f32 v48, v160, v161
    v_cvt_pk_bf16_f32 v49, v162, v163
    s_mov_b32 exec_hi, 0
    buffer_store_dwordx2 v[48:49], v34, s[24:27], s68 offen offset:128
    s_mov_b32 exec_hi, -1
.Lend:
    s_endpgm
.Lra0:
    s_cmp_eq_u32 s69, 0
    s_cbranch_scc1 .Lba0
    s_sub_u32 s69, s69, 1
    buffer_load_dwordx4 v[96:99], v224, s[20:23], s7 offen offset:0 sc1
    buffer_load_dwordx4 v[100:103], v224, s[20:23], s8 offen offset:0 sc1
    buffer_load_dwordx4 v[104:107], v224, s[20:23], s9 offen offset:0 sc1
    buffer_load_dwordx4 v[108:111], v224, s[20:23], s10 offen offset:0 sc1
    s_waitcnt vmcnt(0)
    v_max3_u32 v94, v96, v100, v104
    v_max_u32 v94, v94, v108
    v_cmp_eq_u32 vcc, -1, v94
    s_cbranch_vccnz .Lra0
    s_branch .Lba0
.Lra1:
    s_cmp_eq_u32 s69, 0
    s_cbranch_scc1 .Lba1
    s_sub_u32 s69, s69, 1
    buffer_load_dwordx4 v[112:115], v224, s[20:23], s7 offen offset:1024 sc1
    buffer_load_dwordx4 v[116:119], v224, s[20:23], s8 offen offset:1024 sc1
    buffer_load_dwordx4 v[120:123], v224, s[20:23], s9 offen offset:1024 sc1
    buffer_load_dwordx4 v[124:127], v224, s[20:23], s10 offen offset:1024 sc1
    s_waitcnt vmcnt(0)
    v_max3_u32 v94, v112, v116, v120
    v_max_u32 v94, v94, v124
    v_cmp_eq_u32 vcc, -1, v94
    s_cbranch_vccnz .Lra1
    s_branch .Lba1
.Lra2:
    s_cmp_eq_u32 s69, 0
    s_cbranch_scc1 .Lba2
    s_sub_u32 s69, s69, 1
    buffer_load_dwordx4 v[128:131], v224, s[20:23], s7 offen offset:2048 sc1
    buffer_load_dwordx4 v[132:135], v224, s[20:23], s8 offen offset:2048 sc1
    buffer_load_dwordx4 v[136:139], v224, s[20:23], s9 offen offset:2048 sc1
    buffer_load_dwordx4 v[140:143], v224, s[20:23], s10 offen offset:2048 sc1
    s_waitcnt vmcnt(0)
    v_max3_u32 v94, v128, v132, v136
    v_max_u32 v94, v94, v140
    v_cmp_eq_u32 vcc, -1, v94
    s_cbranch_vccnz .Lra2
    s_branch .Lba2
.Lra3:
    s_cmp_eq_u32 s69, 0
    s_cbranch_scc1 .Lba3
    s_sub_u32 s69, s69, 1
    buffer_load_dwordx4 v[60:63], v224, s[20:23], s7 offen offset:3072 sc1
    buffer_load_dwordx4 v[64:67], v224, s[20:23], s8 offen offset:3072 sc1
    buffer_load_dwordx4 v[68:71], v224, s[20:23], s9 offen offset:3072 sc1
    buffer_load_dwordx4 v[72:75], v224, s[20:23], s10 offen offset:3072 sc1
    s_waitcnt vmcnt(0)
    v_max3_u32 v94, v60, v64, v68
    v_max_u32 v94, v94, v72
    v_cmp_eq_u32 vcc, -1, v94
    s_cbranch_vccnz .Lra3
    s_branch .Lba3
.Lra4:
    s_cmp_eq_u32 s69, 0
    s_cbranch_scc1 .Lba4
    s_sub_u32 s69, s69, 1
    buffer_load_dwordx4 v[76:79], v28, s[20:23], s7 offen offset:0 sc1
    buffer_load_dwordx4 v[80:83], v28, s[20:23], s8 offen offset:0 sc1
    buffer_load_dwordx4 v[84:87], v28, s[20:23], s9 offen offset:0 sc1
    buffer_load_dwordx4 v[88:91], v28, s[20:23], s10 offen offset:0 sc1
    s_waitcnt vmcnt(0)
    v_max3_u32 v94, v76, v80, v84
    v_max_u32 v94, v94, v88
    v_cmp_eq_u32 vcc, -1, v94
    s_cbranch_vccnz .Lra4
    s_branch .Lba4
.Lra5:
    s_cmp_eq_u32 s69, 0
    s_cbranch_scc1 .Lba5
    s_sub_u32 s69, s69, 1
    buffer_load_dwordx4 v[10:13], v28, s[20:23], s7 offen offset:1024 sc1
    buffer_load_dwordx4 v[14:17], v28, s[20:23], s8 offen offset:1024 sc1
    buffer_load_dwordx4 v[18:21], v28, s[20:23], s9 offen offset:1024 sc1
    buffer_load_dwordx4 v[22:25], v28, s[20:23], s10 offen offset:1024 sc1
    s_waitcnt vmcnt(0)
    v_max3_u32 v94, v10, v14, v18
    v_max_u32 v94, v94, v22
    v_cmp_eq_u32 vcc, -1, v94
    s_cbranch_vccnz .Lra5
    s_branch .Lba5
.Lrb0:
    s_cmp_eq_u32 s69, 0
    s_cbranch_scc1 .Lbb0
    s_sub_u32 s69, s69, 1
    buffer_load_dwordx4 v[100:103], v28, s[20:23], s8 offen offset:2048 sc1
    buffer_load_dwordx4 v[116:119], v28, s[20:23], s8 offen offset:3072 sc1
    buffer_load_dwordx4 v[132:135], v29, s[20:23], s8 offen offset:0 sc1
    buffer_load_dwordx4 v[104:107], v28, s[20:23], s9 offen offset:2048 sc1
    buffer_load_dwordx4 v[120:123], v28, s[20:23], s9 offen offset:3072 sc1
    buffer_load_dwordx4 v[136:139], v29, s[20:23], s9 offen offset:0 sc1
    buffer_load_dwordx4 v[108:111], v28, s[20:23], s10 offen offset:2048 sc1
    buffer_load_dwordx4 v[124:127], v28, s[20:23], s10 offen offset:3072 sc1
    buffer_load_dwordx4 v[140:143], v29, s[20:23], s10 offen offset:0 sc1
    buffer_load_dwordx4 v[96:99], v28, s[20:23], s7 offen offset:2048 sc1
    buffer_load_dwordx4 v[112:115], v28, s[20:23], s7 offen offset:3072 sc1
    buffer_load_dwordx4 v[128:131], v29, s[20:23], s7 offen offset:0 sc1
    s_waitcnt vmcnt(0)
    v_max3_u32 v94, v100, v116, v132
    v_cmp_eq_u32 vcc, -1, v94
    s_cbranch_vccnz .Lrb0
    s_branch .Lbb0
.Lrb1:
    s_cmp_eq_u32 s69, 0
    s_cbranch_scc1 .Lbb1
    s_sub_u32 s69, s69, 1
    buffer_load_dwordx4 v[104:107], v28, s[20:23], s9 offen offset:2048 sc1
    buffer_load_dwordx4 v[120:123], v28, s[20:23], s9 offen offset:3072 sc1
    buffer_load_dwordx4 v[136:139], v29, s[20:23], s9 offen offset:0 sc1
    buffer_load_dwordx4 v[108:111], v28, s[20:23], s10 offen offset:2048 sc1
    buffer_load_dwordx4 v[124:127], v28, s[20:23], s10 offen offset:3072 sc1
    buffer_load_dwordx4 v[140:143], v29, s[20:23], s10 offen offset:0 sc1
    buffer_load_dwordx4 v[96:99], v28, s[20:23], s7 offen offset:2048 sc1
    buffer_load_dwordx4 v[112:115], v28, s[20:23], s7 offen offset:3072 sc1
    buffer_load_dwordx4 v[128:131], v29, s[20:23], s7 offen offset:0 sc1
    s_waitcnt vmcnt(0)
    v_max3_u32 v94, v104, v120, v136
    v_cmp_eq_u32 vcc, -1, v94
    s_cbranch_vccnz .Lrb1
    s_branch .Lbb1
.Lrb2:
    s_cmp_eq_u32 s69, 0
    s_cbranch_scc1 .Lbb2
    s_sub_u32 s69, s69, 1
    buffer_load_dwordx4 v[108:111], v28, s[20:23], s10 offen offset:2048 sc1
    buffer_load_dwordx4 v[124:127], v28, s[20:23], s10 offen offset:3072 sc1
    buffer_load_dwordx4 v[140:143], v29, s[20:23], s10 offen offset:0 sc1
    buffer_load_dwordx4 v[96:99], v28, s[20:23], s7 offen offset:2048 sc1
    buffer_load_dwordx4 v[112:115], v28, s[20:23], s7 offen offset:3072 sc1
    buffer_load_dwordx4 v[128:131], v29, s[20:23], s7 offen offset:0 sc1
    s_waitcnt vmcnt(0)
    v_max3_u32 v94, v108, v124, v140
    v_cmp_eq_u32 vcc, -1, v94
    s_cbranch_vccnz .Lrb2
    s_branch .Lbb2
.Lrb3:
    s_cmp_eq_u32 s69, 0
    s_cbranch_scc1 .Lbb3
    s_sub_u32 s69, s69, 1
    buffer_load_dwordx4 v[96:99], v28, s[20:23], s7 offen offset:2048 sc1
    buffer_load_dwordx4 v[112:115], v28, s[20:23], s7 offen offset:3072 sc1
    buffer_load_dwordx4 v[128:131], v29, s[20:23], s7 offen offset:0 sc1
    s_waitcnt vmcnt(0)
    v_max3_u32 v94, v96, v112, v128
    v_cmp_eq_u32 vcc, -1, v94
    s_cbranch_vccnz .Lrb3
    s_branch .Lbb3
    s_endpgm
.Lcodeend:
.section .rodata,"a"
.p2align 6
.amdhsa_kernel gated_mix__linear_kernel_hedgehog__sliding_block__prompt_kernel
  .amdhsa_next_free_vgpr 512
  .amdhsa_next_free_sgpr 102
  .amdhsa_accum_offset 256
  .amdhsa_group_segment_fixed_size 0
  .amdhsa_kernarg_size 88
  .amdhsa_user_sgpr_count 2
  .amdhsa_user_sgpr_kernarg_segment_ptr 1
  .amdhsa_system_sgpr_workgroup_id_x 1
.end_amdhsa_kernel
```
